```python
import torch

def _softmax(x, axis=-1):
    return torch.softmax(x, dim=axis)
def _gelu(x):
    return torch.nn.functional.gelu(x, approximate="tanh")
def _silu(x):
    return torch.nn.functional.silu(x)
def _sigmoid(x):
    return torch.sigmoid(x)
def _layernorm(x, axis=-1, eps=1e-5):
    m = x.mean(dim=axis, keepdim=True)
    v = x.var(dim=axis, keepdim=True, unbiased=False)
    return (x - m) / torch.sqrt(v + eps)
def _scatter_add(tgt, idx, src, axis=0):
    return tgt.clone().index_add_(axis, idx, src)
def _segment_sum(src, seg, n):
    out = torch.zeros((n,) + src.shape[1:], dtype=src.dtype)
    return out.index_add_(0, seg, src)
def _pad(x, pw):
    flat = tuple(v for pair in reversed(pw) for v in pair)
    return torch.nn.functional.pad(x, flat)

kernel_name = 'parallel_sum__grouped_kv_mqa__dense_activation_gelu__prompt'

def setup_inputs():

    _w = (lambda a: (lambda t: t.to(torch.bfloat16) if t.is_floating_point() else t)(torch.as_tensor(a)))
    def _A_setup():
        B, S, D, H = 1, 2048, 512, 32
        Dh = D // H
        return {
            "x": _w((lambda *s: torch.randn(*s, dtype=torch.bfloat16) * 0.05)(B, S, D)),
            "wq": _w((lambda *s: torch.randn(*s, dtype=torch.bfloat16) * 0.05)(D, H * Dh)),
            "wk": _w((lambda *s: torch.randn(*s, dtype=torch.bfloat16) * 0.05)(D, Dh)),
            "wv": _w((lambda *s: torch.randn(*s, dtype=torch.bfloat16) * 0.05)(D, Dh)),
            "wo": _w((lambda *s: torch.randn(*s, dtype=torch.bfloat16) * 0.05)(H * Dh, D)),
        }
    _A_in = _A_setup()

    def _B_setup():
        B, S, D, F = 1, 2048, 512, 1376
        return {
            "x": _w((lambda *s: torch.randn(*s, dtype=torch.bfloat16) * 0.05)(B, S, D)),
            "w1": _w((lambda *s: torch.randn(*s, dtype=torch.bfloat16) * 0.8)(D, F) * (D ** -0.5)),
            "b1": _w((lambda *s: torch.randn(*s, dtype=torch.bfloat16) * 12.8)(F) * 0.01),
            "w2": _w((lambda *s: torch.randn(*s, dtype=torch.bfloat16) * 0.8)(F, D) * (F ** -0.5)),
            "b2": _w((lambda *s: torch.randn(*s, dtype=torch.bfloat16) * 12.8)(D) * 0.01),
        }
    _B_in = _B_setup()

    return {
        "A_x": _A_in["x"],
        "A_wq": _A_in["wq"],
        "A_wk": _A_in["wk"],
        "A_wv": _A_in["wv"],
        "A_wo": _A_in["wo"],
        "B_x": _B_in["x"],
        "B_w1": _B_in["w1"],
        "B_b1": _B_in["b1"],
        "B_w2": _B_in["w2"],
        "B_b2": _B_in["b2"],
    }

def reference(A_x, A_wq, A_wk, A_wv, A_wo, B_x, B_w1, B_b1, B_w2, B_b2):
    def _A_ref(x, wq, wk, wv, wo):
        B, S, D = x.shape
        H = 32
        Dh = D // H
        q = (lambda x, *d: x.permute(*d))((x @ wq).reshape(B, S, H, Dh), 0, 2, 1, 3)
        k = x @ wk
        v = x @ wv
        scores = torch.einsum("bhqd,bkd->bhqk", q, k) * (Dh ** -0.5)
        p = _softmax(scores, axis=-1)
        o = torch.einsum("bhqk,bkd->bhqd", p, v)
        return (lambda x, *d: x.permute(*d))(o, 0, 2, 1, 3).reshape(B, S, H * Dh) @ wo

    def _B_ref(x, w1, b1, w2, b2):
        h = torch.einsum("bsd,df->bsf", x, w1) + b1
        h = _gelu(h)
        return torch.einsum("bsf,fd->bsd", h, w2) + b2

    x = A_x
    xn = _layernorm(x, axis=-1)
    return x + _A_ref(xn, A_wq, A_wk, A_wv, A_wo) + _B_ref(xn, B_w1, B_b1, B_w2, B_b2)
```

```asm
; @launch grid=(256,1,1) block=(768,1,1) lds=163840
.amdgcn_target "amdgcn-amd-amdhsa--gfx950"
.text
.globl parallel_sum__grouped_kv_mqa__dense_activation_gelu__prompt_kernel
.p2align 8
.type parallel_sum__grouped_kv_mqa__dense_activation_gelu__prompt_kernel,@function
parallel_sum__grouped_kv_mqa__dense_activation_gelu__prompt_kernel:

    s_cmp_ge_u32 s2, 256
    s_cbranch_scc1 M_END
    s_load_dwordx16 s[32:47], s[0:1], 0
    s_load_dwordx8 s[48:55], s[0:1], 64
    s_load_dwordx2 s[4:5], s[0:1], 96
    s_and_b32 s14, s2, 7
    s_lshr_b32 s15, s2, 3
    s_getpc_b64 s[16:17]
    s_mov_b32 s18, CODE_END-parallel_sum__grouped_kv_mqa__dense_activation_gelu__prompt_kernel-64
    s_mov_b32 s19, 0x00020000
    s_lshl_b32 s13, s15, 17
    v_lshlrev_b32 v166, 7, v0
    buffer_load_dword v167, v166, s[16:19], s13 offen
    v_lshrrev_b32 v1, 6, v0
    v_and_b32 v2, 63, v0
    v_readfirstlane_b32 s3, v1
    s_lshr_b32 s20, s14, 1
    s_lshl_b32 s20, s20, 2
    s_and_b32 s21, s15, 3
    s_add_u32 s20, s20, s21
    s_and_b32 s21, s14, 1
    s_lshl_b32 s21, s21, 3
    s_lshr_b32 s22, s15, 2
    s_add_u32 s21, s21, s22
    s_and_b32 s12, s3, 3
    s_cmp_lt_u32 s3, 4
    s_cbranch_scc1 M_COMP
    s_cmp_ge_u32 s3, 8
    s_cbranch_scc1 M_G

    s_setprio 3
    v_lshrrev_b32 v20, 3, v2
    v_lshlrev_b32 v20, 10, v20
    v_lshrrev_b32 v21, 4, v2
    v_and_b32 v22, 7, v2
    v_xor_b32 v23, v22, v21
    v_lshl_add_u32 v3, v23, 4, v20
    v_xor_b32 v4, 64, v3
    v_and_b32 v21, 1, v21
    v_lshlrev_b32 v21, 2, v21
    v_xor_b32 v21, v21, v22
    v_lshl_add_u32 v8, v21, 4, v20
    s_lshl_b32 s60, s20, 17
    s_lshl_b32 s22, s12, 15
    s_add_u32 s60, s60, s22
    s_lshl_b32 s62, s12, 14
    s_lshr_b32 s22, s21, 1
    s_lshl_b32 s22, s22, 7
    s_add_u32 s62, s62, s22
    s_mov_b32 s63, 0
    s_mov_b32 s64, 0

    s_movk_i32 s22, 2752
    v_add_u32 v20, 0, v2
    v_mul_u32_u24 v21, 43691, v20
    v_lshrrev_b32 v21, 19, v21
    v_mul_u32_u24 v22, 12, v21
    v_sub_u32 v22, v20, v22
    v_mul_u32_u24 v21, s22, v21
    v_lshl_add_u32 v5, v22, 4, v21
    v_add_u32 v20, 64, v2
    v_mul_u32_u24 v21, 43691, v20
    v_lshrrev_b32 v21, 19, v21
    v_mul_u32_u24 v22, 12, v21
    v_sub_u32 v22, v20, v22
    v_mul_u32_u24 v21, s22, v21
    v_lshl_add_u32 v6, v22, 4, v21
    v_subrev_u32 v6, 1024, v6
    v_add_u32 v20, 128, v2
    v_mul_u32_u24 v21, 43691, v20
    v_lshrrev_b32 v21, 19, v21
    v_mul_u32_u24 v22, 12, v21
    v_sub_u32 v22, v20, v22
    v_mul_u32_u24 v21, s22, v21
    v_lshl_add_u32 v7, v22, 4, v21
    v_subrev_u32 v7, 2048, v7
    s_mul_i32 s61, s12, 44032
    s_mul_i32 s22, s21, 192
    s_add_u32 s61, s61, s22
    s_mov_b32 s26, 2097152
    s_mov_b32 s27, 0x00020000
    s_mov_b32 s58, 524288
    s_mov_b32 s59, 0x00020000
    s_mov_b32 s30, 1409024
    s_mov_b32 s31, 0x00020000
    s_mov_b32 s66, 0
    s_waitcnt lgkmcnt(0)
    s_mov_b64 s[24:25], s[32:33]
    s_mov_b64 s[56:57], s[34:35]
    s_mov_b64 s[28:29], s[44:45]
    s_cmp_eq_u32 s21, 15
    s_cbranch_scc1 M_LDKV
    s_lshl_b32 s22, s12, 12
    s_add_u32 m0, s63, s22
    s_lshl_b32 s23, s66, 7
    s_add_u32 s23, s23, s60
    buffer_load_dwordx4 v3, s[24:27], s23 offen offset:0 lds
    s_add_u32 s23, s23, 7168
    buffer_load_dwordx4 v4, s[24:27], s23 offen offset:1024 lds
    s_add_u32 s23, s23, 7168
    buffer_load_dwordx4 v3, s[24:27], s23 offen offset:2048 lds
    s_add_u32 s23, s23, 7168
    buffer_load_dwordx4 v4, s[24:27], s23 offen offset:3072 lds
    s_mul_i32 s22, s12, 3072
    s_add_u32 s22, s22, s63
    s_add_u32 m0, s22, 16384
    s_mul_i32 s23, s66, 176128
    s_add_u32 s23, s23, s61
    buffer_load_dwordx4 v5, s[28:31], s23 offen offset:0 lds
    buffer_load_dwordx4 v6, s[28:31], s23 offen offset:1024 lds
    buffer_load_dwordx4 v7, s[28:31], s23 offen offset:2048 lds
    s_lshl_b32 s22, s12, 11
    s_add_u32 s22, s22, s63
    s_add_u32 m0, s22, 28672
    s_lshl_b32 s23, s66, 16
    s_add_u32 s23, s23, s62
    buffer_load_dwordx4 v8, s[56:59], s23 offen lds
    s_add_u32 s23, s23, 7168
    buffer_load_dwordx4 v8, s[56:59], s23 offen offset:1024 lds
    s_add_u32 s66, s66, 1
    s_and_b32 s66, s66, 7
    s_add_u32 s63, s63, 36864
    s_cmp_eq_u32 s63, 147456
    s_cselect_b32 s63, 0, s63
M_LDH:
    s_lshl_b32 s22, s12, 12
    s_add_u32 m0, s63, s22
    s_lshl_b32 s23, s66, 7
    s_add_u32 s23, s23, s60
    buffer_load_dwordx4 v3, s[24:27], s23 offen offset:0 lds
    s_add_u32 s23, s23, 7168
    buffer_load_dwordx4 v4, s[24:27], s23 offen offset:1024 lds
    s_add_u32 s23, s23, 7168
    buffer_load_dwordx4 v3, s[24:27], s23 offen offset:2048 lds
    s_add_u32 s23, s23, 7168
    buffer_load_dwordx4 v4, s[24:27], s23 offen offset:3072 lds
    s_mul_i32 s22, s12, 3072
    s_add_u32 s22, s22, s63
    s_add_u32 m0, s22, 16384
    s_mul_i32 s23, s66, 176128
    s_add_u32 s23, s23, s61
    buffer_load_dwordx4 v5, s[28:31], s23 offen offset:0 lds
    buffer_load_dwordx4 v6, s[28:31], s23 offen offset:1024 lds
    buffer_load_dwordx4 v7, s[28:31], s23 offen offset:2048 lds
    s_lshl_b32 s22, s12, 11
    s_add_u32 s22, s22, s63
    s_add_u32 m0, s22, 28672
    s_lshl_b32 s23, s66, 16
    s_add_u32 s23, s23, s62
    buffer_load_dwordx4 v8, s[56:59], s23 offen lds
    s_add_u32 s23, s23, 7168
    buffer_load_dwordx4 v8, s[56:59], s23 offen offset:1024 lds
    s_add_u32 s66, s66, 1
    s_and_b32 s66, s66, 7
    s_add_u32 s63, s63, 36864
    s_cmp_eq_u32 s63, 147456
    s_cselect_b32 s63, 0, s63
    s_waitcnt vmcnt(9)
    s_barrier
    s_add_u32 s64, s64, 1
    s_cmp_lt_u32 s64, 7
    s_cbranch_scc1 M_LDH
    s_waitcnt vmcnt(0)
    s_barrier
    s_branch M_LDX
M_LDKV:
    s_cmp_lt_u32 s12, 2
    s_cselect_b32 s28, s36, s38
    s_cselect_b32 s29, s37, s39
    s_mov_b32 s30, 16384
    s_mov_b32 s31, 0x00020000
    v_lshlrev_b32 v5, 4, v2
    s_and_b32 s61, s12, 1
    s_lshl_b32 s61, s61, 10
    s_lshl_b32 s63, s12, 12
    s_lshl_b32 s64, s12, 10
    s_lshl_b32 s66, s12, 11
    s_lshl_b32 s22, s12, 14
    s_sub_u32 s67, s60, s22
    s_add_u32 s67, s67, 65536
    s_add_u32 m0, s63, 0
    s_add_u32 s23, s60, 0
    buffer_load_dwordx4 v3, s[24:27], s23 offen offset:0 lds
    s_add_u32 s23, s23, 7168
    buffer_load_dwordx4 v4, s[24:27], s23 offen offset:1024 lds
    s_add_u32 s23, s23, 7168
    buffer_load_dwordx4 v3, s[24:27], s23 offen offset:2048 lds
    s_add_u32 s23, s23, 7168
    buffer_load_dwordx4 v4, s[24:27], s23 offen offset:3072 lds
    s_add_u32 m0, s64, 16384
    s_add_u32 s23, s61, 0
    buffer_load_dwordx4 v5, s[28:31], s23 offen lds
    s_add_u32 m0, s63, 36864
    s_add_u32 s23, s60, 128
    buffer_load_dwordx4 v3, s[24:27], s23 offen offset:0 lds
    s_add_u32 s23, s23, 7168
    buffer_load_dwordx4 v4, s[24:27], s23 offen offset:1024 lds
    s_add_u32 s23, s23, 7168
    buffer_load_dwordx4 v3, s[24:27], s23 offen offset:2048 lds
    s_add_u32 s23, s23, 7168
    buffer_load_dwordx4 v4, s[24:27], s23 offen offset:3072 lds
    s_add_u32 m0, s64, 53248
    s_add_u32 s23, s61, 2048
    buffer_load_dwordx4 v5, s[28:31], s23 offen lds
    s_add_u32 m0, s63, 73728
    s_add_u32 s23, s60, 256
    buffer_load_dwordx4 v3, s[24:27], s23 offen offset:0 lds
    s_add_u32 s23, s23, 7168
    buffer_load_dwordx4 v4, s[24:27], s23 offen offset:1024 lds
    s_add_u32 s23, s23, 7168
    buffer_load_dwordx4 v3, s[24:27], s23 offen offset:2048 lds
    s_add_u32 s23, s23, 7168
    buffer_load_dwordx4 v4, s[24:27], s23 offen offset:3072 lds
    s_add_u32 m0, s64, 90112
    s_add_u32 s23, s61, 4096
    buffer_load_dwordx4 v5, s[28:31], s23 offen lds
    s_waitcnt vmcnt(10)
    s_barrier
    s_add_u32 m0, s63, 110592
    s_add_u32 s23, s60, 384
    buffer_load_dwordx4 v3, s[24:27], s23 offen offset:0 lds
    s_add_u32 s23, s23, 7168
    buffer_load_dwordx4 v4, s[24:27], s23 offen offset:1024 lds
    s_add_u32 s23, s23, 7168
    buffer_load_dwordx4 v3, s[24:27], s23 offen offset:2048 lds
    s_add_u32 s23, s23, 7168
    buffer_load_dwordx4 v4, s[24:27], s23 offen offset:3072 lds
    s_add_u32 m0, s64, 126976
    s_add_u32 s23, s61, 6144
    buffer_load_dwordx4 v5, s[28:31], s23 offen lds
    s_waitcnt vmcnt(10)
    s_barrier
    s_add_u32 m0, s63, 0
    s_add_u32 s23, s60, 512
    buffer_load_dwordx4 v3, s[24:27], s23 offen offset:0 lds
    s_add_u32 s23, s23, 7168
    buffer_load_dwordx4 v4, s[24:27], s23 offen offset:1024 lds
    s_add_u32 s23, s23, 7168
    buffer_load_dwordx4 v3, s[24:27], s23 offen offset:2048 lds
    s_add_u32 s23, s23, 7168
    buffer_load_dwordx4 v4, s[24:27], s23 offen offset:3072 lds
    s_add_u32 m0, s64, 16384
    s_add_u32 s23, s61, 8192
    buffer_load_dwordx4 v5, s[28:31], s23 offen lds
    s_waitcnt vmcnt(10)
    s_barrier
    s_add_u32 m0, s63, 36864
    s_add_u32 s23, s60, 640
    buffer_load_dwordx4 v3, s[24:27], s23 offen offset:0 lds
    s_add_u32 s23, s23, 7168
    buffer_load_dwordx4 v4, s[24:27], s23 offen offset:1024 lds
    s_add_u32 s23, s23, 7168
    buffer_load_dwordx4 v3, s[24:27], s23 offen offset:2048 lds
    s_add_u32 s23, s23, 7168
    buffer_load_dwordx4 v4, s[24:27], s23 offen offset:3072 lds
    s_add_u32 m0, s64, 53248
    s_add_u32 s23, s61, 10240
    buffer_load_dwordx4 v5, s[28:31], s23 offen lds
    s_waitcnt vmcnt(10)
    s_barrier
    s_add_u32 m0, s63, 73728
    s_add_u32 s23, s60, 768
    buffer_load_dwordx4 v3, s[24:27], s23 offen offset:0 lds
    s_add_u32 s23, s23, 7168
    buffer_load_dwordx4 v4, s[24:27], s23 offen offset:1024 lds
    s_add_u32 s23, s23, 7168
    buffer_load_dwordx4 v3, s[24:27], s23 offen offset:2048 lds
    s_add_u32 s23, s23, 7168
    buffer_load_dwordx4 v4, s[24:27], s23 offen offset:3072 lds
    s_add_u32 m0, s64, 90112
    s_add_u32 s23, s61, 12288
    buffer_load_dwordx4 v5, s[28:31], s23 offen lds
    s_waitcnt vmcnt(10)
    s_barrier
    s_add_u32 m0, s63, 110592
    s_add_u32 s23, s60, 896
    buffer_load_dwordx4 v3, s[24:27], s23 offen offset:0 lds
    s_add_u32 s23, s23, 7168
    buffer_load_dwordx4 v4, s[24:27], s23 offen offset:1024 lds
    s_add_u32 s23, s23, 7168
    buffer_load_dwordx4 v3, s[24:27], s23 offen offset:2048 lds
    s_add_u32 s23, s23, 7168
    buffer_load_dwordx4 v4, s[24:27], s23 offen offset:3072 lds
    s_add_u32 m0, s64, 126976
    s_add_u32 s23, s61, 14336
    buffer_load_dwordx4 v5, s[28:31], s23 offen lds
    s_waitcnt vmcnt(10)
    s_barrier
    s_add_u32 m0, s66, 8192
    s_add_u32 s23, s67, 0
    buffer_load_dwordx4 v3, s[24:27], s23 offen lds
    s_add_u32 s23, s23, 7168
    buffer_load_dwordx4 v4, s[24:27], s23 offen offset:1024 lds
    s_add_u32 m0, s66, 28672
    s_add_u32 s23, s62, 0
    buffer_load_dwordx4 v8, s[56:59], s23 offen lds
    s_add_u32 s23, s23, 7168
    buffer_load_dwordx4 v8, s[56:59], s23 offen offset:1024 lds
    s_waitcnt vmcnt(9)
    s_barrier
    s_add_u32 m0, s66, 45056
    s_add_u32 s23, s67, 128
    buffer_load_dwordx4 v3, s[24:27], s23 offen lds
    s_add_u32 s23, s23, 7168
    buffer_load_dwordx4 v4, s[24:27], s23 offen offset:1024 lds
    s_add_u32 m0, s66, 65536
    s_add_u32 s23, s62, 65536
    buffer_load_dwordx4 v8, s[56:59], s23 offen lds
    s_add_u32 s23, s23, 7168
    buffer_load_dwordx4 v8, s[56:59], s23 offen offset:1024 lds
    s_waitcnt vmcnt(8)
    s_barrier
    s_add_u32 m0, s66, 81920
    s_add_u32 s23, s67, 256
    buffer_load_dwordx4 v3, s[24:27], s23 offen lds
    s_add_u32 s23, s23, 7168
    buffer_load_dwordx4 v4, s[24:27], s23 offen offset:1024 lds
    s_add_u32 m0, s66, 102400
    s_add_u32 s23, s62, 131072
    buffer_load_dwordx4 v8, s[56:59], s23 offen lds
    s_add_u32 s23, s23, 7168
    buffer_load_dwordx4 v8, s[56:59], s23 offen offset:1024 lds
    s_waitcnt vmcnt(8)
    s_barrier
    s_add_u32 m0, s66, 118784
    s_add_u32 s23, s67, 384
    buffer_load_dwordx4 v3, s[24:27], s23 offen lds
    s_add_u32 s23, s23, 7168
    buffer_load_dwordx4 v4, s[24:27], s23 offen offset:1024 lds
    s_add_u32 m0, s66, 139264
    s_add_u32 s23, s62, 196608
    buffer_load_dwordx4 v8, s[56:59], s23 offen lds
    s_add_u32 s23, s23, 7168
    buffer_load_dwordx4 v8, s[56:59], s23 offen offset:1024 lds
    s_waitcnt vmcnt(8)
    s_barrier
    s_add_u32 m0, s66, 8192
    s_add_u32 s23, s67, 512
    buffer_load_dwordx4 v3, s[24:27], s23 offen lds
    s_add_u32 s23, s23, 7168
    buffer_load_dwordx4 v4, s[24:27], s23 offen offset:1024 lds
    s_add_u32 m0, s66, 28672
    s_add_u32 s23, s62, 262144
    buffer_load_dwordx4 v8, s[56:59], s23 offen lds
    s_add_u32 s23, s23, 7168
    buffer_load_dwordx4 v8, s[56:59], s23 offen offset:1024 lds
    s_waitcnt vmcnt(8)
    s_barrier
    s_add_u32 m0, s66, 45056
    s_add_u32 s23, s67, 640
    buffer_load_dwordx4 v3, s[24:27], s23 offen lds
    s_add_u32 s23, s23, 7168
    buffer_load_dwordx4 v4, s[24:27], s23 offen offset:1024 lds
    s_add_u32 m0, s66, 65536
    s_add_u32 s23, s62, 327680
    buffer_load_dwordx4 v8, s[56:59], s23 offen lds
    s_add_u32 s23, s23, 7168
    buffer_load_dwordx4 v8, s[56:59], s23 offen offset:1024 lds
    s_waitcnt vmcnt(8)
    s_barrier
    s_add_u32 m0, s66, 81920
    s_add_u32 s23, s67, 768
    buffer_load_dwordx4 v3, s[24:27], s23 offen lds
    s_add_u32 s23, s23, 7168
    buffer_load_dwordx4 v4, s[24:27], s23 offen offset:1024 lds
    s_add_u32 m0, s66, 102400
    s_add_u32 s23, s62, 393216
    buffer_load_dwordx4 v8, s[56:59], s23 offen lds
    s_add_u32 s23, s23, 7168
    buffer_load_dwordx4 v8, s[56:59], s23 offen offset:1024 lds
    s_waitcnt vmcnt(8)
    s_barrier
    s_add_u32 m0, s66, 118784
    s_add_u32 s23, s67, 896
    buffer_load_dwordx4 v3, s[24:27], s23 offen lds
    s_add_u32 s23, s23, 7168
    buffer_load_dwordx4 v4, s[24:27], s23 offen offset:1024 lds
    s_add_u32 m0, s66, 139264
    s_add_u32 s23, s62, 458752
    buffer_load_dwordx4 v8, s[56:59], s23 offen lds
    s_add_u32 s23, s23, 7168
    buffer_load_dwordx4 v8, s[56:59], s23 offen offset:1024 lds
    s_waitcnt vmcnt(8)
    s_barrier
    s_waitcnt vmcnt(4)
    s_barrier
    s_waitcnt vmcnt(0)
    s_barrier
M_LDX:
    s_add_u32 s8, s4, 0x3fffff
    s_addc_u32 s9, s5, 0
    s_and_b32 s8, s8, 0xffc00000
    s_mov_b32 s10, 16777216
    s_mov_b32 s11, 0x00020000
    s_barrier
    s_mov_b32 s65, 0
    s_branch M_ATT
M_COMP:
    s_setprio 3
    s_and_b32 s22, s12, 1
    s_lshl_b32 s22, s22, 1
    s_lshr_b32 s58, s12, 1
    s_or_b32 s22, s22, s58
    s_and_b32 s23, s21, 1
    s_lshl_b32 s23, s23, 1
    s_and_b32 s13, s12, 1
    s_add_u32 s23, s23, s13
    s_mov_b32 s56, -1
    s_mov_b32 s57, 0
    v_and_b32 v3, 31, v2
    v_lshrrev_b32 v4, 5, v2
    v_bfe_u32 v5, v2, 1, 3
    v_xor_b32 v5, v5, v4
    v_lshlrev_b32 v5, 4, v5
    v_lshl_add_u32 v5, v3, 7, v5
    s_lshl_b32 s13, s12, 12
    s_lshl_b32 s59, s22, 5
    s_or_b32 s13, s13, s59
    v_xor_b32 v8, s13, v5
    v_xor_b32 v9, 32, v8
    v_xor_b32 v10, 64, v8
    v_xor_b32 v11, 96, v8
    s_xor_b32 s13, s12, s23
    s_lshl_b32 s13, s13, 12
    v_xor_b32 v12, s13, v8
    v_xor_b32 v13, s13, v9
    v_xor_b32 v14, s13, v10
    v_xor_b32 v15, s13, v11
    v_bfe_u32 v5, v2, 2, 2
    v_lshl_add_u32 v6, v4, 3, v5
    v_bfe_u32 v7, v2, 4, 1
    v_bfe_u32 v154, v2, 1, 1
    v_lshl_add_u32 v154, v7, 1, v154
    v_bfe_u32 v155, v2, 3, 1
    v_lshlrev_b32 v155, 2, v155
    s_lshl_b32 s13, s58, 2
    v_xor_b32 v155, s13, v155
    v_or_b32 v154, v154, v155
    v_lshlrev_b32 v154, 4, v154
    v_lshl_add_u32 v154, v6, 7, v154
    v_and_b32 v155, 1, v2
    v_lshl_add_u32 v154, v155, 3, v154
    v_add_u32 v154, 28672, v154
    v_and_b32 v155, 3, v2
    v_mov_b32 v150, 0x3f803f80

    s_xor_b32 s13, s22, 0
    s_lshl_b32 s13, s13, 11
    v_add_u32 v20, s13, v154
    s_xor_b32 s13, s22, 1
    s_lshl_b32 s13, s13, 11
    v_add_u32 v21, s13, v154
    s_xor_b32 s13, s22, 2
    s_lshl_b32 s13, s13, 11
    v_add_u32 v22, s13, v154
    s_xor_b32 s13, s22, 3
    s_lshl_b32 s13, s13, 11
    v_add_u32 v23, s13, v154
    v_mov_b32 v144, 0
    v_mov_b32 v145, 0
    v_mov_b32 v146, 0
    v_mov_b32 v147, 0
    v_mov_b32 v148, 0
    v_mov_b32 v149, 0
    v_mov_b32 v80, 0
    v_mov_b32 v81, 0
    v_mov_b32 v82, 0
    v_mov_b32 v83, 0
    v_mov_b32 v84, 0
    v_mov_b32 v85, 0
    v_mov_b32 v86, 0
    v_mov_b32 v87, 0
    v_mov_b32 v88, 0
    v_mov_b32 v89, 0
    v_mov_b32 v90, 0
    v_mov_b32 v91, 0
    v_mov_b32 v92, 0
    v_mov_b32 v93, 0
    v_mov_b32 v94, 0
    v_mov_b32 v95, 0
    v_mov_b32 v96, 0
    v_mov_b32 v97, 0
    v_mov_b32 v98, 0
    v_mov_b32 v99, 0
    v_mov_b32 v100, 0
    v_mov_b32 v101, 0
    v_mov_b32 v102, 0
    v_mov_b32 v103, 0
    v_mov_b32 v104, 0
    v_mov_b32 v105, 0
    v_mov_b32 v106, 0
    v_mov_b32 v107, 0
    v_mov_b32 v108, 0
    v_mov_b32 v109, 0
    v_mov_b32 v110, 0
    v_mov_b32 v111, 0
    v_mov_b32 v112, 0
    v_mov_b32 v113, 0
    v_mov_b32 v114, 0
    v_mov_b32 v115, 0
    v_mov_b32 v116, 0
    v_mov_b32 v117, 0
    v_mov_b32 v118, 0
    v_mov_b32 v119, 0
    v_mov_b32 v120, 0
    v_mov_b32 v121, 0
    v_mov_b32 v122, 0
    v_mov_b32 v123, 0
    v_mov_b32 v124, 0
    v_mov_b32 v125, 0
    v_mov_b32 v126, 0
    v_mov_b32 v127, 0
    v_mov_b32 v128, 0
    v_mov_b32 v129, 0
    v_mov_b32 v130, 0
    v_mov_b32 v131, 0
    v_mov_b32 v132, 0
    v_mov_b32 v133, 0
    v_mov_b32 v134, 0
    v_mov_b32 v135, 0
    v_mov_b32 v136, 0
    v_mov_b32 v137, 0
    v_mov_b32 v138, 0
    v_mov_b32 v139, 0
    v_mov_b32 v140, 0
    v_mov_b32 v141, 0
    v_mov_b32 v142, 0
    v_mov_b32 v143, 0
    s_waitcnt lgkmcnt(0)
    s_add_u32 s8, s4, 0x3fffff
    s_addc_u32 s9, s5, 0
    s_and_b32 s8, s8, 0xffc00000
    s_mov_b32 s10, 16777216
    s_mov_b32 s11, 0x00020000
    s_cmp_eq_u32 s21, 15
    s_cbranch_scc1 M_CKV
    v_mul_u32_u24 v156, 192, v6
    v_lshl_add_u32 v156, v7, 5, v156
    v_lshl_add_u32 v156, v155, 3, v156
    v_add_u32 v156, 16384, v156
    s_xor_b32 s13, s22, 0
    s_mul_i32 s13, s13, 3072
    v_add_u32 v16, s13, v156
    s_xor_b32 s13, s22, 1
    s_mul_i32 s13, s13, 3072
    v_add_u32 v17, s13, v156
    s_xor_b32 s13, s22, 2
    s_mul_i32 s13, s13, 3072
    v_add_u32 v18, s13, v156
    s_xor_b32 s13, s22, 3
    s_mul_i32 s13, s13, 3072
    v_add_u32 v19, s13, v156
    s_mov_b32 s24, s46
    s_mov_b32 s25, s47
    s_mov_b32 s26, 2752
    s_mov_b32 s27, 0x00020000
    v_lshlrev_b32 v157, 1, v3
    s_mul_i32 s13, s21, 192
    buffer_load_ushort v151, v157, s[24:27], s13 offen offset:0
    buffer_load_ushort v152, v157, s[24:27], s13 offen offset:64
    buffer_load_ushort v153, v157, s[24:27], s13 offen offset:128
    s_barrier
    ds_read_b128 v[24:27], v8 offset:0
    ds_read_b64_tr_b16 v[44:45], v16 offset:0
    ds_read_b64_tr_b16 v[46:47], v16 offset:768
    ds_read_b128 v[40:43], v12 offset:0
    ds_read_b64_tr_b16 v[56:57], v20 offset:0
    ds_read_b64_tr_b16 v[58:59], v20 offset:512
    ds_read_b64_tr_b16 v[48:49], v16 offset:64
    ds_read_b64_tr_b16 v[50:51], v16 offset:832
    ds_read_b64_tr_b16 v[52:53], v16 offset:128
    ds_read_b64_tr_b16 v[54:55], v16 offset:896
    ds_read_b128 v[28:31], v9 offset:0
    ds_read_b64_tr_b16 v[64:65], v17 offset:0
    ds_read_b64_tr_b16 v[66:67], v17 offset:768
    ds_read_b128 v[60:63], v13 offset:0
    ds_read_b64_tr_b16 v[76:77], v21 offset:0
    ds_read_b64_tr_b16 v[78:79], v21 offset:512
    ds_read_b64_tr_b16 v[68:69], v17 offset:64
    ds_read_b64_tr_b16 v[70:71], v17 offset:832
    ds_read_b64_tr_b16 v[72:73], v17 offset:128
    ds_read_b64_tr_b16 v[74:75], v17 offset:896
    s_waitcnt lgkmcnt(15)
    v_mfma_f32_32x32x16_bf16 v[80:95], v[44:47], v[24:27], v[80:95]
    ds_read_b128 v[32:35], v10 offset:0
    s_waitcnt lgkmcnt(15)
    v_mfma_f32_32x32x16_bf16 v[128:143], v[56:59], v[40:43], v[128:143]
    ds_read_b128 v[36:39], v11 offset:0
    s_waitcnt lgkmcnt(14)
    v_mfma_f32_32x32x16_bf16 v[96:111], v[48:51], v[24:27], v[96:111]
    s_waitcnt lgkmcnt(12)
    v_mfma_f32_32x32x16_bf16 v[112:127], v[52:55], v[24:27], v[112:127]
    s_waitcnt lgkmcnt(9)
    v_mfma_f32_32x32x16_bf16 v[80:95], v[64:67], v[28:31], v[80:95]
    ds_read_b64_tr_b16 v[44:45], v18 offset:0
    ds_read_b64_tr_b16 v[46:47], v18 offset:768
    ds_read_b128 v[40:43], v14 offset:0
    s_waitcnt lgkmcnt(9)
    v_mfma_f32_32x32x16_bf16 v[128:143], v[76:79], v[60:63], v[128:143]
    ds_read_b64_tr_b16 v[56:57], v22 offset:0
    ds_read_b64_tr_b16 v[58:59], v22 offset:512
    ds_read_b64_tr_b16 v[48:49], v18 offset:64
    s_waitcnt lgkmcnt(10)
    v_mfma_f32_32x32x16_bf16 v[96:111], v[68:71], v[28:31], v[96:111]
    ds_read_b64_tr_b16 v[50:51], v18 offset:832
    ds_read_b64_tr_b16 v[52:53], v18 offset:128
    ds_read_b64_tr_b16 v[54:55], v18 offset:896
    s_waitcnt lgkmcnt(11)
    v_mfma_f32_32x32x16_bf16 v[112:127], v[72:75], v[28:31], v[112:127]
    s_waitcnt lgkmcnt(7)
    v_mfma_f32_32x32x16_bf16 v[80:95], v[44:47], v[32:35], v[80:95]
    ds_read_b64_tr_b16 v[64:65], v19 offset:0
    ds_read_b64_tr_b16 v[66:67], v19 offset:768
    ds_read_b128 v[60:63], v15 offset:0
    s_waitcnt lgkmcnt(7)
    v_mfma_f32_32x32x16_bf16 v[128:143], v[56:59], v[40:43], v[128:143]
    ds_read_b64_tr_b16 v[76:77], v23 offset:0
    ds_read_b64_tr_b16 v[78:79], v23 offset:512
    ds_read_b64_tr_b16 v[68:69], v19 offset:64
    s_waitcnt lgkmcnt(8)
    v_mfma_f32_32x32x16_bf16 v[96:111], v[48:51], v[32:35], v[96:111]
    ds_read_b64_tr_b16 v[70:71], v19 offset:832
    ds_read_b64_tr_b16 v[72:73], v19 offset:128
    ds_read_b64_tr_b16 v[74:75], v19 offset:896
    s_waitcnt lgkmcnt(9)
    v_mfma_f32_32x32x16_bf16 v[112:127], v[52:55], v[32:35], v[112:127]
    s_waitcnt lgkmcnt(7)
    v_mfma_f32_32x32x16_bf16 v[80:95], v[64:67], v[36:39], v[80:95]
    s_waitcnt lgkmcnt(0)
    s_barrier
    v_mfma_f32_32x32x16_bf16 v[128:143], v[76:79], v[60:63], v[128:143]
    v_mfma_f32_32x32x16_bf16 v[96:111], v[68:71], v[36:39], v[96:111]
    v_mfma_f32_32x32x16_bf16 v[112:127], v[72:75], v[36:39], v[112:127]
    v_dot2_f32_bf16 v149, v56, v150, v149
    v_dot2_f32_bf16 v149, v57, v150, v149
    v_dot2_f32_bf16 v149, v58, v150, v149
    v_dot2_f32_bf16 v149, v59, v150, v149
    v_dot2_f32_bf16 v145, v24, v24, v145
    v_dot2_f32_bf16 v144, v24, v150, v144
    v_dot2_f32_bf16 v145, v25, v25, v145
    v_dot2_f32_bf16 v144, v25, v150, v144
    v_dot2_f32_bf16 v145, v26, v26, v145
    v_dot2_f32_bf16 v144, v26, v150, v144
    v_dot2_f32_bf16 v145, v27, v27, v145
    v_dot2_f32_bf16 v144, v27, v150, v144
    ds_read_b128 v[24:27], v8 offset:36864
    v_dot2_f32_bf16 v146, v64, v150, v146
    ds_read_b64_tr_b16 v[44:45], v16 offset:36864
    v_dot2_f32_bf16 v147, v68, v150, v147
    ds_read_b64_tr_b16 v[46:47], v16 offset:37632
    v_dot2_f32_bf16 v148, v72, v150, v148
    ds_read_b128 v[40:43], v12 offset:36864
    v_dot2_f32_bf16 v146, v65, v150, v146
    ds_read_b64_tr_b16 v[56:57], v20 offset:36864
    v_dot2_f32_bf16 v147, v69, v150, v147
    ds_read_b64_tr_b16 v[58:59], v20 offset:37376
    v_dot2_f32_bf16 v148, v73, v150, v148
    ds_read_b64_tr_b16 v[48:49], v16 offset:36928
    v_dot2_f32_bf16 v146, v66, v150, v146
    ds_read_b64_tr_b16 v[50:51], v16 offset:37696
    v_dot2_f32_bf16 v147, v70, v150, v147
    ds_read_b64_tr_b16 v[52:53], v16 offset:36992
    v_dot2_f32_bf16 v148, v74, v150, v148
    ds_read_b64_tr_b16 v[54:55], v16 offset:37760
    v_dot2_f32_bf16 v146, v67, v150, v146
    v_dot2_f32_bf16 v147, v71, v150, v147
    v_dot2_f32_bf16 v148, v75, v150, v148
    v_dot2_f32_bf16 v149, v76, v150, v149
    v_dot2_f32_bf16 v149, v77, v150, v149
    v_dot2_f32_bf16 v149, v78, v150, v149
    v_dot2_f32_bf16 v149, v79, v150, v149
    v_dot2_f32_bf16 v145, v28, v28, v145
    v_dot2_f32_bf16 v144, v28, v150, v144
    v_dot2_f32_bf16 v145, v29, v29, v145
    v_dot2_f32_bf16 v144, v29, v150, v144
    v_dot2_f32_bf16 v145, v30, v30, v145
    v_dot2_f32_bf16 v144, v30, v150, v144
    v_dot2_f32_bf16 v145, v31, v31, v145
    v_dot2_f32_bf16 v144, v31, v150, v144
    ds_read_b128 v[28:31], v9 offset:36864
    v_dot2_f32_bf16 v145, v32, v32, v145
    ds_read_b64_tr_b16 v[64:65], v17 offset:36864
    v_dot2_f32_bf16 v144, v32, v150, v144
    ds_read_b64_tr_b16 v[66:67], v17 offset:37632
    v_dot2_f32_bf16 v145, v33, v33, v145
    ds_read_b128 v[60:63], v13 offset:36864
    v_dot2_f32_bf16 v144, v33, v150, v144
    ds_read_b64_tr_b16 v[76:77], v21 offset:36864
    v_dot2_f32_bf16 v145, v34, v34, v145
    ds_read_b64_tr_b16 v[78:79], v21 offset:37376
    v_dot2_f32_bf16 v144, v34, v150, v144
    ds_read_b64_tr_b16 v[68:69], v17 offset:36928
    v_dot2_f32_bf16 v145, v35, v35, v145
    ds_read_b64_tr_b16 v[70:71], v17 offset:37696
    v_dot2_f32_bf16 v144, v35, v150, v144
    ds_read_b64_tr_b16 v[72:73], v17 offset:36992
    v_dot2_f32_bf16 v145, v36, v36, v145
    ds_read_b64_tr_b16 v[74:75], v17 offset:37760
    v_dot2_f32_bf16 v144, v36, v150, v144
    v_dot2_f32_bf16 v145, v37, v37, v145
    v_dot2_f32_bf16 v144, v37, v150, v144
    v_dot2_f32_bf16 v145, v38, v38, v145
    v_dot2_f32_bf16 v144, v38, v150, v144
    v_dot2_f32_bf16 v145, v39, v39, v145
    v_dot2_f32_bf16 v144, v39, v150, v144
    s_waitcnt lgkmcnt(15)
    v_mfma_f32_32x32x16_bf16 v[80:95], v[44:47], v[24:27], v[80:95]
    ds_read_b128 v[32:35], v10 offset:36864
    s_waitcnt lgkmcnt(15)
    v_mfma_f32_32x32x16_bf16 v[128:143], v[56:59], v[40:43], v[128:143]
    ds_read_b128 v[36:39], v11 offset:36864
    s_waitcnt lgkmcnt(14)
    v_mfma_f32_32x32x16_bf16 v[96:111], v[48:51], v[24:27], v[96:111]
    s_waitcnt lgkmcnt(12)
    v_mfma_f32_32x32x16_bf16 v[112:127], v[52:55], v[24:27], v[112:127]
    s_waitcnt lgkmcnt(9)
    v_mfma_f32_32x32x16_bf16 v[80:95], v[64:67], v[28:31], v[80:95]
    ds_read_b64_tr_b16 v[44:45], v18 offset:36864
    ds_read_b64_tr_b16 v[46:47], v18 offset:37632
    ds_read_b128 v[40:43], v14 offset:36864
    s_waitcnt lgkmcnt(9)
    v_mfma_f32_32x32x16_bf16 v[128:143], v[76:79], v[60:63], v[128:143]
    ds_read_b64_tr_b16 v[56:57], v22 offset:36864
    ds_read_b64_tr_b16 v[58:59], v22 offset:37376
    ds_read_b64_tr_b16 v[48:49], v18 offset:36928
    s_waitcnt lgkmcnt(10)
    v_mfma_f32_32x32x16_bf16 v[96:111], v[68:71], v[28:31], v[96:111]
    ds_read_b64_tr_b16 v[50:51], v18 offset:37696
    ds_read_b64_tr_b16 v[52:53], v18 offset:36992
    ds_read_b64_tr_b16 v[54:55], v18 offset:37760
    s_waitcnt lgkmcnt(11)
    v_mfma_f32_32x32x16_bf16 v[112:127], v[72:75], v[28:31], v[112:127]
    s_waitcnt lgkmcnt(7)
    v_mfma_f32_32x32x16_bf16 v[80:95], v[44:47], v[32:35], v[80:95]
    ds_read_b64_tr_b16 v[64:65], v19 offset:36864
    ds_read_b64_tr_b16 v[66:67], v19 offset:37632
    ds_read_b128 v[60:63], v15 offset:36864
    s_waitcnt lgkmcnt(7)
    v_mfma_f32_32x32x16_bf16 v[128:143], v[56:59], v[40:43], v[128:143]
    ds_read_b64_tr_b16 v[76:77], v23 offset:36864
    ds_read_b64_tr_b16 v[78:79], v23 offset:37376
    ds_read_b64_tr_b16 v[68:69], v19 offset:36928
    s_waitcnt lgkmcnt(8)
    v_mfma_f32_32x32x16_bf16 v[96:111], v[48:51], v[32:35], v[96:111]
    ds_read_b64_tr_b16 v[70:71], v19 offset:37696
    ds_read_b64_tr_b16 v[72:73], v19 offset:36992
    ds_read_b64_tr_b16 v[74:75], v19 offset:37760
    s_waitcnt lgkmcnt(9)
    v_mfma_f32_32x32x16_bf16 v[112:127], v[52:55], v[32:35], v[112:127]
    s_waitcnt lgkmcnt(7)
    v_mfma_f32_32x32x16_bf16 v[80:95], v[64:67], v[36:39], v[80:95]
    s_waitcnt lgkmcnt(0)
    s_barrier
    v_mfma_f32_32x32x16_bf16 v[128:143], v[76:79], v[60:63], v[128:143]
    v_mfma_f32_32x32x16_bf16 v[96:111], v[68:71], v[36:39], v[96:111]
    v_mfma_f32_32x32x16_bf16 v[112:127], v[72:75], v[36:39], v[112:127]
    v_add_u32 v8, 73728, v8
    v_add_u32 v9, 73728, v9
    v_add_u32 v10, 73728, v10
    v_add_u32 v11, 73728, v11
    v_add_u32 v12, 73728, v12
    v_add_u32 v13, 73728, v13
    v_add_u32 v14, 73728, v14
    v_add_u32 v15, 73728, v15
    v_add_u32 v16, 73728, v16
    v_add_u32 v17, 73728, v17
    v_add_u32 v18, 73728, v18
    v_add_u32 v19, 73728, v19
    v_add_u32 v20, 73728, v20
    v_add_u32 v21, 73728, v21
    v_add_u32 v22, 73728, v22
    v_add_u32 v23, 73728, v23
    v_dot2_f32_bf16 v149, v56, v150, v149
    v_dot2_f32_bf16 v149, v57, v150, v149
    v_dot2_f32_bf16 v149, v58, v150, v149
    v_dot2_f32_bf16 v149, v59, v150, v149
    v_dot2_f32_bf16 v145, v24, v24, v145
    v_dot2_f32_bf16 v144, v24, v150, v144
    v_dot2_f32_bf16 v145, v25, v25, v145
    v_dot2_f32_bf16 v144, v25, v150, v144
    v_dot2_f32_bf16 v145, v26, v26, v145
    v_dot2_f32_bf16 v144, v26, v150, v144
    v_dot2_f32_bf16 v145, v27, v27, v145
    v_dot2_f32_bf16 v144, v27, v150, v144
    ds_read_b128 v[24:27], v8 offset:0
    v_dot2_f32_bf16 v146, v64, v150, v146
    ds_read_b64_tr_b16 v[44:45], v16 offset:0
    v_dot2_f32_bf16 v147, v68, v150, v147
    ds_read_b64_tr_b16 v[46:47], v16 offset:768
    v_dot2_f32_bf16 v148, v72, v150, v148
    ds_read_b128 v[40:43], v12 offset:0
    v_dot2_f32_bf16 v146, v65, v150, v146
    ds_read_b64_tr_b16 v[56:57], v20 offset:0
    v_dot2_f32_bf16 v147, v69, v150, v147
    ds_read_b64_tr_b16 v[58:59], v20 offset:512
    v_dot2_f32_bf16 v148, v73, v150, v148
    ds_read_b64_tr_b16 v[48:49], v16 offset:64
    v_dot2_f32_bf16 v146, v66, v150, v146
    ds_read_b64_tr_b16 v[50:51], v16 offset:832
    v_dot2_f32_bf16 v147, v70, v150, v147
    ds_read_b64_tr_b16 v[52:53], v16 offset:128
    v_dot2_f32_bf16 v148, v74, v150, v148
    ds_read_b64_tr_b16 v[54:55], v16 offset:896
    v_dot2_f32_bf16 v146, v67, v150, v146
    v_dot2_f32_bf16 v147, v71, v150, v147
    v_dot2_f32_bf16 v148, v75, v150, v148
    v_dot2_f32_bf16 v149, v76, v150, v149
    v_dot2_f32_bf16 v149, v77, v150, v149
    v_dot2_f32_bf16 v149, v78, v150, v149
    v_dot2_f32_bf16 v149, v79, v150, v149
    v_dot2_f32_bf16 v145, v28, v28, v145
    v_dot2_f32_bf16 v144, v28, v150, v144
    v_dot2_f32_bf16 v145, v29, v29, v145
    v_dot2_f32_bf16 v144, v29, v150, v144
    v_dot2_f32_bf16 v145, v30, v30, v145
    v_dot2_f32_bf16 v144, v30, v150, v144
    v_dot2_f32_bf16 v145, v31, v31, v145
    v_dot2_f32_bf16 v144, v31, v150, v144
    ds_read_b128 v[28:31], v9 offset:0
    v_dot2_f32_bf16 v145, v32, v32, v145
    ds_read_b64_tr_b16 v[64:65], v17 offset:0
    v_dot2_f32_bf16 v144, v32, v150, v144
    ds_read_b64_tr_b16 v[66:67], v17 offset:768
    v_dot2_f32_bf16 v145, v33, v33, v145
    ds_read_b128 v[60:63], v13 offset:0
    v_dot2_f32_bf16 v144, v33, v150, v144
    ds_read_b64_tr_b16 v[76:77], v21 offset:0
    v_dot2_f32_bf16 v145, v34, v34, v145
    ds_read_b64_tr_b16 v[78:79], v21 offset:512
    v_dot2_f32_bf16 v144, v34, v150, v144
    ds_read_b64_tr_b16 v[68:69], v17 offset:64
    v_dot2_f32_bf16 v145, v35, v35, v145
    ds_read_b64_tr_b16 v[70:71], v17 offset:832
    v_dot2_f32_bf16 v144, v35, v150, v144
    ds_read_b64_tr_b16 v[72:73], v17 offset:128
    v_dot2_f32_bf16 v145, v36, v36, v145
    ds_read_b64_tr_b16 v[74:75], v17 offset:896
    v_dot2_f32_bf16 v144, v36, v150, v144
    v_dot2_f32_bf16 v145, v37, v37, v145
    v_dot2_f32_bf16 v144, v37, v150, v144
    v_dot2_f32_bf16 v145, v38, v38, v145
    v_dot2_f32_bf16 v144, v38, v150, v144
    v_dot2_f32_bf16 v145, v39, v39, v145
    v_dot2_f32_bf16 v144, v39, v150, v144
    s_waitcnt lgkmcnt(15)
    v_mfma_f32_32x32x16_bf16 v[80:95], v[44:47], v[24:27], v[80:95]
    ds_read_b128 v[32:35], v10 offset:0
    s_waitcnt lgkmcnt(15)
    v_mfma_f32_32x32x16_bf16 v[128:143], v[56:59], v[40:43], v[128:143]
    ds_read_b128 v[36:39], v11 offset:0
    s_waitcnt lgkmcnt(14)
    v_mfma_f32_32x32x16_bf16 v[96:111], v[48:51], v[24:27], v[96:111]
    s_waitcnt lgkmcnt(12)
    v_mfma_f32_32x32x16_bf16 v[112:127], v[52:55], v[24:27], v[112:127]
    s_waitcnt lgkmcnt(9)
    v_mfma_f32_32x32x16_bf16 v[80:95], v[64:67], v[28:31], v[80:95]
    ds_read_b64_tr_b16 v[44:45], v18 offset:0
    ds_read_b64_tr_b16 v[46:47], v18 offset:768
    ds_read_b128 v[40:43], v14 offset:0
    s_waitcnt lgkmcnt(9)
    v_mfma_f32_32x32x16_bf16 v[128:143], v[76:79], v[60:63], v[128:143]
    ds_read_b64_tr_b16 v[56:57], v22 offset:0
    ds_read_b64_tr_b16 v[58:59], v22 offset:512
    ds_read_b64_tr_b16 v[48:49], v18 offset:64
    s_waitcnt lgkmcnt(10)
    v_mfma_f32_32x32x16_bf16 v[96:111], v[68:71], v[28:31], v[96:111]
    ds_read_b64_tr_b16 v[50:51], v18 offset:832
    ds_read_b64_tr_b16 v[52:53], v18 offset:128
    ds_read_b64_tr_b16 v[54:55], v18 offset:896
    s_waitcnt lgkmcnt(11)
    v_mfma_f32_32x32x16_bf16 v[112:127], v[72:75], v[28:31], v[112:127]
    s_waitcnt lgkmcnt(7)
    v_mfma_f32_32x32x16_bf16 v[80:95], v[44:47], v[32:35], v[80:95]
    ds_read_b64_tr_b16 v[64:65], v19 offset:0
    ds_read_b64_tr_b16 v[66:67], v19 offset:768
    ds_read_b128 v[60:63], v15 offset:0
    s_waitcnt lgkmcnt(7)
    v_mfma_f32_32x32x16_bf16 v[128:143], v[56:59], v[40:43], v[128:143]
    ds_read_b64_tr_b16 v[76:77], v23 offset:0
    ds_read_b64_tr_b16 v[78:79], v23 offset:512
    ds_read_b64_tr_b16 v[68:69], v19 offset:64
    s_waitcnt lgkmcnt(8)
    v_mfma_f32_32x32x16_bf16 v[96:111], v[48:51], v[32:35], v[96:111]
    ds_read_b64_tr_b16 v[70:71], v19 offset:832
    ds_read_b64_tr_b16 v[72:73], v19 offset:128
    ds_read_b64_tr_b16 v[74:75], v19 offset:896
    s_waitcnt lgkmcnt(9)
    v_mfma_f32_32x32x16_bf16 v[112:127], v[52:55], v[32:35], v[112:127]
    s_waitcnt lgkmcnt(7)
    v_mfma_f32_32x32x16_bf16 v[80:95], v[64:67], v[36:39], v[80:95]
    s_waitcnt lgkmcnt(0)
    s_barrier
    v_mfma_f32_32x32x16_bf16 v[128:143], v[76:79], v[60:63], v[128:143]
    v_mfma_f32_32x32x16_bf16 v[96:111], v[68:71], v[36:39], v[96:111]
    v_mfma_f32_32x32x16_bf16 v[112:127], v[72:75], v[36:39], v[112:127]
    v_dot2_f32_bf16 v149, v56, v150, v149
    v_dot2_f32_bf16 v149, v57, v150, v149
    v_dot2_f32_bf16 v149, v58, v150, v149
    v_dot2_f32_bf16 v149, v59, v150, v149
    v_dot2_f32_bf16 v145, v24, v24, v145
    v_dot2_f32_bf16 v144, v24, v150, v144
    v_dot2_f32_bf16 v145, v25, v25, v145
    v_dot2_f32_bf16 v144, v25, v150, v144
    v_dot2_f32_bf16 v145, v26, v26, v145
    v_dot2_f32_bf16 v144, v26, v150, v144
    v_dot2_f32_bf16 v145, v27, v27, v145
    v_dot2_f32_bf16 v144, v27, v150, v144
    ds_read_b128 v[24:27], v8 offset:36864
    v_dot2_f32_bf16 v146, v64, v150, v146
    ds_read_b64_tr_b16 v[44:45], v16 offset:36864
    v_dot2_f32_bf16 v147, v68, v150, v147
    ds_read_b64_tr_b16 v[46:47], v16 offset:37632
    v_dot2_f32_bf16 v148, v72, v150, v148
    ds_read_b128 v[40:43], v12 offset:36864
    v_dot2_f32_bf16 v146, v65, v150, v146
    ds_read_b64_tr_b16 v[56:57], v20 offset:36864
    v_dot2_f32_bf16 v147, v69, v150, v147
    ds_read_b64_tr_b16 v[58:59], v20 offset:37376
    v_dot2_f32_bf16 v148, v73, v150, v148
    ds_read_b64_tr_b16 v[48:49], v16 offset:36928
    v_dot2_f32_bf16 v146, v66, v150, v146
    ds_read_b64_tr_b16 v[50:51], v16 offset:37696
    v_dot2_f32_bf16 v147, v70, v150, v147
    ds_read_b64_tr_b16 v[52:53], v16 offset:36992
    v_dot2_f32_bf16 v148, v74, v150, v148
    ds_read_b64_tr_b16 v[54:55], v16 offset:37760
    v_dot2_f32_bf16 v146, v67, v150, v146
    v_dot2_f32_bf16 v147, v71, v150, v147
    v_dot2_f32_bf16 v148, v75, v150, v148
    v_dot2_f32_bf16 v149, v76, v150, v149
    v_dot2_f32_bf16 v149, v77, v150, v149
    v_dot2_f32_bf16 v149, v78, v150, v149
    v_dot2_f32_bf16 v149, v79, v150, v149
    v_dot2_f32_bf16 v145, v28, v28, v145
    v_dot2_f32_bf16 v144, v28, v150, v144
    v_dot2_f32_bf16 v145, v29, v29, v145
    v_dot2_f32_bf16 v144, v29, v150, v144
    v_dot2_f32_bf16 v145, v30, v30, v145
    v_dot2_f32_bf16 v144, v30, v150, v144
    v_dot2_f32_bf16 v145, v31, v31, v145
    v_dot2_f32_bf16 v144, v31, v150, v144
    ds_read_b128 v[28:31], v9 offset:36864
    v_dot2_f32_bf16 v145, v32, v32, v145
    ds_read_b64_tr_b16 v[64:65], v17 offset:36864
    v_dot2_f32_bf16 v144, v32, v150, v144
    ds_read_b64_tr_b16 v[66:67], v17 offset:37632
    v_dot2_f32_bf16 v145, v33, v33, v145
    ds_read_b128 v[60:63], v13 offset:36864
    v_dot2_f32_bf16 v144, v33, v150, v144
    ds_read_b64_tr_b16 v[76:77], v21 offset:36864
    v_dot2_f32_bf16 v145, v34, v34, v145
    ds_read_b64_tr_b16 v[78:79], v21 offset:37376
    v_dot2_f32_bf16 v144, v34, v150, v144
    ds_read_b64_tr_b16 v[68:69], v17 offset:36928
    v_dot2_f32_bf16 v145, v35, v35, v145
    ds_read_b64_tr_b16 v[70:71], v17 offset:37696
    v_dot2_f32_bf16 v144, v35, v150, v144
    ds_read_b64_tr_b16 v[72:73], v17 offset:36992
    v_dot2_f32_bf16 v145, v36, v36, v145
    ds_read_b64_tr_b16 v[74:75], v17 offset:37760
    v_dot2_f32_bf16 v144, v36, v150, v144
    v_dot2_f32_bf16 v145, v37, v37, v145
    v_dot2_f32_bf16 v144, v37, v150, v144
    v_dot2_f32_bf16 v145, v38, v38, v145
    v_dot2_f32_bf16 v144, v38, v150, v144
    v_dot2_f32_bf16 v145, v39, v39, v145
    v_dot2_f32_bf16 v144, v39, v150, v144
    s_waitcnt lgkmcnt(15)
    v_mfma_f32_32x32x16_bf16 v[80:95], v[44:47], v[24:27], v[80:95]
    ds_read_b128 v[32:35], v10 offset:36864
    s_waitcnt lgkmcnt(15)
    v_mfma_f32_32x32x16_bf16 v[128:143], v[56:59], v[40:43], v[128:143]
    ds_read_b128 v[36:39], v11 offset:36864
    s_waitcnt lgkmcnt(14)
    v_mfma_f32_32x32x16_bf16 v[96:111], v[48:51], v[24:27], v[96:111]
    s_waitcnt lgkmcnt(12)
    v_mfma_f32_32x32x16_bf16 v[112:127], v[52:55], v[24:27], v[112:127]
    s_waitcnt lgkmcnt(9)
    v_mfma_f32_32x32x16_bf16 v[80:95], v[64:67], v[28:31], v[80:95]
    ds_read_b64_tr_b16 v[44:45], v18 offset:36864
    ds_read_b64_tr_b16 v[46:47], v18 offset:37632
    ds_read_b128 v[40:43], v14 offset:36864
    s_waitcnt lgkmcnt(9)
    v_mfma_f32_32x32x16_bf16 v[128:143], v[76:79], v[60:63], v[128:143]
    ds_read_b64_tr_b16 v[56:57], v22 offset:36864
    ds_read_b64_tr_b16 v[58:59], v22 offset:37376
    ds_read_b64_tr_b16 v[48:49], v18 offset:36928
    s_waitcnt lgkmcnt(10)
    v_mfma_f32_32x32x16_bf16 v[96:111], v[68:71], v[28:31], v[96:111]
    ds_read_b64_tr_b16 v[50:51], v18 offset:37696
    ds_read_b64_tr_b16 v[52:53], v18 offset:36992
    ds_read_b64_tr_b16 v[54:55], v18 offset:37760
    s_waitcnt lgkmcnt(11)
    v_mfma_f32_32x32x16_bf16 v[112:127], v[72:75], v[28:31], v[112:127]
    s_waitcnt lgkmcnt(7)
    v_mfma_f32_32x32x16_bf16 v[80:95], v[44:47], v[32:35], v[80:95]
    ds_read_b64_tr_b16 v[64:65], v19 offset:36864
    ds_read_b64_tr_b16 v[66:67], v19 offset:37632
    ds_read_b128 v[60:63], v15 offset:36864
    s_waitcnt lgkmcnt(7)
    v_mfma_f32_32x32x16_bf16 v[128:143], v[56:59], v[40:43], v[128:143]
    ds_read_b64_tr_b16 v[76:77], v23 offset:36864
    ds_read_b64_tr_b16 v[78:79], v23 offset:37376
    ds_read_b64_tr_b16 v[68:69], v19 offset:36928
    s_waitcnt lgkmcnt(8)
    v_mfma_f32_32x32x16_bf16 v[96:111], v[48:51], v[32:35], v[96:111]
    ds_read_b64_tr_b16 v[70:71], v19 offset:37696
    ds_read_b64_tr_b16 v[72:73], v19 offset:36992
    ds_read_b64_tr_b16 v[74:75], v19 offset:37760
    s_waitcnt lgkmcnt(9)
    v_mfma_f32_32x32x16_bf16 v[112:127], v[52:55], v[32:35], v[112:127]
    s_waitcnt lgkmcnt(7)
    v_mfma_f32_32x32x16_bf16 v[80:95], v[64:67], v[36:39], v[80:95]
    s_waitcnt lgkmcnt(0)
    s_barrier
    v_mfma_f32_32x32x16_bf16 v[128:143], v[76:79], v[60:63], v[128:143]
    v_mfma_f32_32x32x16_bf16 v[96:111], v[68:71], v[36:39], v[96:111]
    v_mfma_f32_32x32x16_bf16 v[112:127], v[72:75], v[36:39], v[112:127]
    v_add_u32 v8, -73728, v8
    v_add_u32 v9, -73728, v9
    v_add_u32 v10, -73728, v10
    v_add_u32 v11, -73728, v11
    v_add_u32 v12, -73728, v12
    v_add_u32 v13, -73728, v13
    v_add_u32 v14, -73728, v14
    v_add_u32 v15, -73728, v15
    v_add_u32 v16, -73728, v16
    v_add_u32 v17, -73728, v17
    v_add_u32 v18, -73728, v18
    v_add_u32 v19, -73728, v19
    v_add_u32 v20, -73728, v20
    v_add_u32 v21, -73728, v21
    v_add_u32 v22, -73728, v22
    v_add_u32 v23, -73728, v23
    v_dot2_f32_bf16 v149, v56, v150, v149
    v_dot2_f32_bf16 v149, v57, v150, v149
    v_dot2_f32_bf16 v149, v58, v150, v149
    v_dot2_f32_bf16 v149, v59, v150, v149
    v_dot2_f32_bf16 v145, v24, v24, v145
    v_dot2_f32_bf16 v144, v24, v150, v144
    v_dot2_f32_bf16 v145, v25, v25, v145
    v_dot2_f32_bf16 v144, v25, v150, v144
    v_dot2_f32_bf16 v145, v26, v26, v145
    v_dot2_f32_bf16 v144, v26, v150, v144
    v_dot2_f32_bf16 v145, v27, v27, v145
    v_dot2_f32_bf16 v144, v27, v150, v144
    ds_read_b128 v[24:27], v8 offset:0
    v_dot2_f32_bf16 v146, v64, v150, v146
    ds_read_b64_tr_b16 v[44:45], v16 offset:0
    v_dot2_f32_bf16 v147, v68, v150, v147
    ds_read_b64_tr_b16 v[46:47], v16 offset:768
    v_dot2_f32_bf16 v148, v72, v150, v148
    ds_read_b128 v[40:43], v12 offset:0
    v_dot2_f32_bf16 v146, v65, v150, v146
    ds_read_b64_tr_b16 v[56:57], v20 offset:0
    v_dot2_f32_bf16 v147, v69, v150, v147
    ds_read_b64_tr_b16 v[58:59], v20 offset:512
    v_dot2_f32_bf16 v148, v73, v150, v148
    ds_read_b64_tr_b16 v[48:49], v16 offset:64
    v_dot2_f32_bf16 v146, v66, v150, v146
    ds_read_b64_tr_b16 v[50:51], v16 offset:832
    v_dot2_f32_bf16 v147, v70, v150, v147
    ds_read_b64_tr_b16 v[52:53], v16 offset:128
    v_dot2_f32_bf16 v148, v74, v150, v148
    ds_read_b64_tr_b16 v[54:55], v16 offset:896
    v_dot2_f32_bf16 v146, v67, v150, v146
    v_dot2_f32_bf16 v147, v71, v150, v147
    v_dot2_f32_bf16 v148, v75, v150, v148
    v_dot2_f32_bf16 v149, v76, v150, v149
    v_dot2_f32_bf16 v149, v77, v150, v149
    v_dot2_f32_bf16 v149, v78, v150, v149
    v_dot2_f32_bf16 v149, v79, v150, v149
    v_dot2_f32_bf16 v145, v28, v28, v145
    v_dot2_f32_bf16 v144, v28, v150, v144
    v_dot2_f32_bf16 v145, v29, v29, v145
    v_dot2_f32_bf16 v144, v29, v150, v144
    v_dot2_f32_bf16 v145, v30, v30, v145
    v_dot2_f32_bf16 v144, v30, v150, v144
    v_dot2_f32_bf16 v145, v31, v31, v145
    v_dot2_f32_bf16 v144, v31, v150, v144
    ds_read_b128 v[28:31], v9 offset:0
    v_dot2_f32_bf16 v145, v32, v32, v145
    ds_read_b64_tr_b16 v[64:65], v17 offset:0
    v_dot2_f32_bf16 v144, v32, v150, v144
    ds_read_b64_tr_b16 v[66:67], v17 offset:768
    v_dot2_f32_bf16 v145, v33, v33, v145
    ds_read_b128 v[60:63], v13 offset:0
    v_dot2_f32_bf16 v144, v33, v150, v144
    ds_read_b64_tr_b16 v[76:77], v21 offset:0
    v_dot2_f32_bf16 v145, v34, v34, v145
    ds_read_b64_tr_b16 v[78:79], v21 offset:512
    v_dot2_f32_bf16 v144, v34, v150, v144
    ds_read_b64_tr_b16 v[68:69], v17 offset:64
    v_dot2_f32_bf16 v145, v35, v35, v145
    ds_read_b64_tr_b16 v[70:71], v17 offset:832
    v_dot2_f32_bf16 v144, v35, v150, v144
    ds_read_b64_tr_b16 v[72:73], v17 offset:128
    v_dot2_f32_bf16 v145, v36, v36, v145
    ds_read_b64_tr_b16 v[74:75], v17 offset:896
    v_dot2_f32_bf16 v144, v36, v150, v144
    v_dot2_f32_bf16 v145, v37, v37, v145
    v_dot2_f32_bf16 v144, v37, v150, v144
    v_dot2_f32_bf16 v145, v38, v38, v145
    v_dot2_f32_bf16 v144, v38, v150, v144
    v_dot2_f32_bf16 v145, v39, v39, v145
    v_dot2_f32_bf16 v144, v39, v150, v144
    s_waitcnt lgkmcnt(15)
    v_mfma_f32_32x32x16_bf16 v[80:95], v[44:47], v[24:27], v[80:95]
    ds_read_b128 v[32:35], v10 offset:0
    s_waitcnt lgkmcnt(15)
    v_mfma_f32_32x32x16_bf16 v[128:143], v[56:59], v[40:43], v[128:143]
    ds_read_b128 v[36:39], v11 offset:0
    s_waitcnt lgkmcnt(14)
    v_mfma_f32_32x32x16_bf16 v[96:111], v[48:51], v[24:27], v[96:111]
    s_waitcnt lgkmcnt(12)
    v_mfma_f32_32x32x16_bf16 v[112:127], v[52:55], v[24:27], v[112:127]
    s_waitcnt lgkmcnt(9)
    v_mfma_f32_32x32x16_bf16 v[80:95], v[64:67], v[28:31], v[80:95]
    ds_read_b64_tr_b16 v[44:45], v18 offset:0
    ds_read_b64_tr_b16 v[46:47], v18 offset:768
    ds_read_b128 v[40:43], v14 offset:0
    s_waitcnt lgkmcnt(9)
    v_mfma_f32_32x32x16_bf16 v[128:143], v[76:79], v[60:63], v[128:143]
    ds_read_b64_tr_b16 v[56:57], v22 offset:0
    ds_read_b64_tr_b16 v[58:59], v22 offset:512
    ds_read_b64_tr_b16 v[48:49], v18 offset:64
    s_waitcnt lgkmcnt(10)
    v_mfma_f32_32x32x16_bf16 v[96:111], v[68:71], v[28:31], v[96:111]
    ds_read_b64_tr_b16 v[50:51], v18 offset:832
    ds_read_b64_tr_b16 v[52:53], v18 offset:128
    ds_read_b64_tr_b16 v[54:55], v18 offset:896
    s_waitcnt lgkmcnt(11)
    v_mfma_f32_32x32x16_bf16 v[112:127], v[72:75], v[28:31], v[112:127]
    s_waitcnt lgkmcnt(7)
    v_mfma_f32_32x32x16_bf16 v[80:95], v[44:47], v[32:35], v[80:95]
    ds_read_b64_tr_b16 v[64:65], v19 offset:0
    ds_read_b64_tr_b16 v[66:67], v19 offset:768
    ds_read_b128 v[60:63], v15 offset:0
    s_waitcnt lgkmcnt(7)
    v_mfma_f32_32x32x16_bf16 v[128:143], v[56:59], v[40:43], v[128:143]
    ds_read_b64_tr_b16 v[76:77], v23 offset:0
    ds_read_b64_tr_b16 v[78:79], v23 offset:512
    ds_read_b64_tr_b16 v[68:69], v19 offset:64
    s_waitcnt lgkmcnt(8)
    v_mfma_f32_32x32x16_bf16 v[96:111], v[48:51], v[32:35], v[96:111]
    ds_read_b64_tr_b16 v[70:71], v19 offset:832
    ds_read_b64_tr_b16 v[72:73], v19 offset:128
    ds_read_b64_tr_b16 v[74:75], v19 offset:896
    s_waitcnt lgkmcnt(9)
    v_mfma_f32_32x32x16_bf16 v[112:127], v[52:55], v[32:35], v[112:127]
    s_waitcnt lgkmcnt(7)
    v_mfma_f32_32x32x16_bf16 v[80:95], v[64:67], v[36:39], v[80:95]
    s_waitcnt lgkmcnt(0)
    s_barrier
    v_mfma_f32_32x32x16_bf16 v[128:143], v[76:79], v[60:63], v[128:143]
    v_mfma_f32_32x32x16_bf16 v[96:111], v[68:71], v[36:39], v[96:111]
    v_mfma_f32_32x32x16_bf16 v[112:127], v[72:75], v[36:39], v[112:127]
    v_dot2_f32_bf16 v149, v56, v150, v149
    v_dot2_f32_bf16 v149, v57, v150, v149
    v_dot2_f32_bf16 v149, v58, v150, v149
    v_dot2_f32_bf16 v149, v59, v150, v149
    v_dot2_f32_bf16 v145, v24, v24, v145
    v_dot2_f32_bf16 v144, v24, v150, v144
    v_dot2_f32_bf16 v145, v25, v25, v145
    v_dot2_f32_bf16 v144, v25, v150, v144
    v_dot2_f32_bf16 v145, v26, v26, v145
    v_dot2_f32_bf16 v144, v26, v150, v144
    v_dot2_f32_bf16 v145, v27, v27, v145
    v_dot2_f32_bf16 v144, v27, v150, v144
    ds_read_b128 v[24:27], v8 offset:36864
    v_dot2_f32_bf16 v146, v64, v150, v146
    ds_read_b64_tr_b16 v[44:45], v16 offset:36864
    v_dot2_f32_bf16 v147, v68, v150, v147
    ds_read_b64_tr_b16 v[46:47], v16 offset:37632
    v_dot2_f32_bf16 v148, v72, v150, v148
    ds_read_b128 v[40:43], v12 offset:36864
    v_dot2_f32_bf16 v146, v65, v150, v146
    ds_read_b64_tr_b16 v[56:57], v20 offset:36864
    v_dot2_f32_bf16 v147, v69, v150, v147
    ds_read_b64_tr_b16 v[58:59], v20 offset:37376
    v_dot2_f32_bf16 v148, v73, v150, v148
    ds_read_b64_tr_b16 v[48:49], v16 offset:36928
    v_dot2_f32_bf16 v146, v66, v150, v146
    ds_read_b64_tr_b16 v[50:51], v16 offset:37696
    v_dot2_f32_bf16 v147, v70, v150, v147
    ds_read_b64_tr_b16 v[52:53], v16 offset:36992
    v_dot2_f32_bf16 v148, v74, v150, v148
    ds_read_b64_tr_b16 v[54:55], v16 offset:37760
    v_dot2_f32_bf16 v146, v67, v150, v146
    v_dot2_f32_bf16 v147, v71, v150, v147
    v_dot2_f32_bf16 v148, v75, v150, v148
    v_dot2_f32_bf16 v149, v76, v150, v149
    v_dot2_f32_bf16 v149, v77, v150, v149
    v_dot2_f32_bf16 v149, v78, v150, v149
    v_dot2_f32_bf16 v149, v79, v150, v149
    v_dot2_f32_bf16 v145, v28, v28, v145
    v_dot2_f32_bf16 v144, v28, v150, v144
    v_dot2_f32_bf16 v145, v29, v29, v145
    v_dot2_f32_bf16 v144, v29, v150, v144
    v_dot2_f32_bf16 v145, v30, v30, v145
    v_dot2_f32_bf16 v144, v30, v150, v144
    v_dot2_f32_bf16 v145, v31, v31, v145
    v_dot2_f32_bf16 v144, v31, v150, v144
    ds_read_b128 v[28:31], v9 offset:36864
    v_dot2_f32_bf16 v145, v32, v32, v145
    ds_read_b64_tr_b16 v[64:65], v17 offset:36864
    v_dot2_f32_bf16 v144, v32, v150, v144
    ds_read_b64_tr_b16 v[66:67], v17 offset:37632
    v_dot2_f32_bf16 v145, v33, v33, v145
    ds_read_b128 v[60:63], v13 offset:36864
    v_dot2_f32_bf16 v144, v33, v150, v144
    ds_read_b64_tr_b16 v[76:77], v21 offset:36864
    v_dot2_f32_bf16 v145, v34, v34, v145
    ds_read_b64_tr_b16 v[78:79], v21 offset:37376
    v_dot2_f32_bf16 v144, v34, v150, v144
    ds_read_b64_tr_b16 v[68:69], v17 offset:36928
    v_dot2_f32_bf16 v145, v35, v35, v145
    ds_read_b64_tr_b16 v[70:71], v17 offset:37696
    v_dot2_f32_bf16 v144, v35, v150, v144
    ds_read_b64_tr_b16 v[72:73], v17 offset:36992
    v_dot2_f32_bf16 v145, v36, v36, v145
    ds_read_b64_tr_b16 v[74:75], v17 offset:37760
    v_dot2_f32_bf16 v144, v36, v150, v144
    v_dot2_f32_bf16 v145, v37, v37, v145
    v_dot2_f32_bf16 v144, v37, v150, v144
    v_dot2_f32_bf16 v145, v38, v38, v145
    v_dot2_f32_bf16 v144, v38, v150, v144
    v_dot2_f32_bf16 v145, v39, v39, v145
    v_dot2_f32_bf16 v144, v39, v150, v144
    s_waitcnt lgkmcnt(15)
    v_mfma_f32_32x32x16_bf16 v[80:95], v[44:47], v[24:27], v[80:95]
    ds_read_b128 v[32:35], v10 offset:36864
    s_waitcnt lgkmcnt(15)
    v_mfma_f32_32x32x16_bf16 v[128:143], v[56:59], v[40:43], v[128:143]
    ds_read_b128 v[36:39], v11 offset:36864
    s_waitcnt lgkmcnt(14)
    v_mfma_f32_32x32x16_bf16 v[96:111], v[48:51], v[24:27], v[96:111]
    s_waitcnt lgkmcnt(12)
    v_mfma_f32_32x32x16_bf16 v[112:127], v[52:55], v[24:27], v[112:127]
    s_waitcnt lgkmcnt(9)
    v_mfma_f32_32x32x16_bf16 v[80:95], v[64:67], v[28:31], v[80:95]
    ds_read_b64_tr_b16 v[44:45], v18 offset:36864
    ds_read_b64_tr_b16 v[46:47], v18 offset:37632
    ds_read_b128 v[40:43], v14 offset:36864
    s_waitcnt lgkmcnt(9)
    v_mfma_f32_32x32x16_bf16 v[128:143], v[76:79], v[60:63], v[128:143]
    ds_read_b64_tr_b16 v[56:57], v22 offset:36864
    ds_read_b64_tr_b16 v[58:59], v22 offset:37376
    ds_read_b64_tr_b16 v[48:49], v18 offset:36928
    s_waitcnt lgkmcnt(10)
    v_mfma_f32_32x32x16_bf16 v[96:111], v[68:71], v[28:31], v[96:111]
    ds_read_b64_tr_b16 v[50:51], v18 offset:37696
    ds_read_b64_tr_b16 v[52:53], v18 offset:36992
    ds_read_b64_tr_b16 v[54:55], v18 offset:37760
    s_waitcnt lgkmcnt(11)
    v_mfma_f32_32x32x16_bf16 v[112:127], v[72:75], v[28:31], v[112:127]
    s_waitcnt lgkmcnt(7)
    v_mfma_f32_32x32x16_bf16 v[80:95], v[44:47], v[32:35], v[80:95]
    ds_read_b64_tr_b16 v[64:65], v19 offset:36864
    ds_read_b64_tr_b16 v[66:67], v19 offset:37632
    ds_read_b128 v[60:63], v15 offset:36864
    s_waitcnt lgkmcnt(7)
    v_mfma_f32_32x32x16_bf16 v[128:143], v[56:59], v[40:43], v[128:143]
    ds_read_b64_tr_b16 v[76:77], v23 offset:36864
    ds_read_b64_tr_b16 v[78:79], v23 offset:37376
    ds_read_b64_tr_b16 v[68:69], v19 offset:36928
    s_waitcnt lgkmcnt(8)
    v_mfma_f32_32x32x16_bf16 v[96:111], v[48:51], v[32:35], v[96:111]
    ds_read_b64_tr_b16 v[70:71], v19 offset:37696
    ds_read_b64_tr_b16 v[72:73], v19 offset:36992
    ds_read_b64_tr_b16 v[74:75], v19 offset:37760
    s_waitcnt lgkmcnt(9)
    v_mfma_f32_32x32x16_bf16 v[112:127], v[52:55], v[32:35], v[112:127]
    s_waitcnt lgkmcnt(7)
    v_mfma_f32_32x32x16_bf16 v[80:95], v[64:67], v[36:39], v[80:95]
    s_waitcnt lgkmcnt(0)
    s_barrier
    v_mfma_f32_32x32x16_bf16 v[128:143], v[76:79], v[60:63], v[128:143]
    v_mfma_f32_32x32x16_bf16 v[96:111], v[68:71], v[36:39], v[96:111]
    v_mfma_f32_32x32x16_bf16 v[112:127], v[72:75], v[36:39], v[112:127]
    v_add_u32 v8, 73728, v8
    v_add_u32 v9, 73728, v9
    v_add_u32 v10, 73728, v10
    v_add_u32 v11, 73728, v11
    v_add_u32 v12, 73728, v12
    v_add_u32 v13, 73728, v13
    v_add_u32 v14, 73728, v14
    v_add_u32 v15, 73728, v15
    v_add_u32 v16, 73728, v16
    v_add_u32 v17, 73728, v17
    v_add_u32 v18, 73728, v18
    v_add_u32 v19, 73728, v19
    v_add_u32 v20, 73728, v20
    v_add_u32 v21, 73728, v21
    v_add_u32 v22, 73728, v22
    v_add_u32 v23, 73728, v23
    v_dot2_f32_bf16 v149, v56, v150, v149
    v_dot2_f32_bf16 v149, v57, v150, v149
    v_dot2_f32_bf16 v149, v58, v150, v149
    v_dot2_f32_bf16 v149, v59, v150, v149
    v_dot2_f32_bf16 v145, v24, v24, v145
    v_dot2_f32_bf16 v144, v24, v150, v144
    v_dot2_f32_bf16 v145, v25, v25, v145
    v_dot2_f32_bf16 v144, v25, v150, v144
    v_dot2_f32_bf16 v145, v26, v26, v145
    v_dot2_f32_bf16 v144, v26, v150, v144
    v_dot2_f32_bf16 v145, v27, v27, v145
    v_dot2_f32_bf16 v144, v27, v150, v144
    ds_read_b128 v[24:27], v8 offset:0
    v_dot2_f32_bf16 v146, v64, v150, v146
    ds_read_b64_tr_b16 v[44:45], v16 offset:0
    v_dot2_f32_bf16 v147, v68, v150, v147
    ds_read_b64_tr_b16 v[46:47], v16 offset:768
    v_dot2_f32_bf16 v148, v72, v150, v148
    ds_read_b128 v[40:43], v12 offset:0
    v_dot2_f32_bf16 v146, v65, v150, v146
    ds_read_b64_tr_b16 v[56:57], v20 offset:0
    v_dot2_f32_bf16 v147, v69, v150, v147
    ds_read_b64_tr_b16 v[58:59], v20 offset:512
    v_dot2_f32_bf16 v148, v73, v150, v148
    ds_read_b64_tr_b16 v[48:49], v16 offset:64
    v_dot2_f32_bf16 v146, v66, v150, v146
    ds_read_b64_tr_b16 v[50:51], v16 offset:832
    v_dot2_f32_bf16 v147, v70, v150, v147
    ds_read_b64_tr_b16 v[52:53], v16 offset:128
    v_dot2_f32_bf16 v148, v74, v150, v148
    ds_read_b64_tr_b16 v[54:55], v16 offset:896
    v_dot2_f32_bf16 v146, v67, v150, v146
    v_dot2_f32_bf16 v147, v71, v150, v147
    v_dot2_f32_bf16 v148, v75, v150, v148
    v_dot2_f32_bf16 v149, v76, v150, v149
    v_dot2_f32_bf16 v149, v77, v150, v149
    v_dot2_f32_bf16 v149, v78, v150, v149
    v_dot2_f32_bf16 v149, v79, v150, v149
    v_dot2_f32_bf16 v145, v28, v28, v145
    v_dot2_f32_bf16 v144, v28, v150, v144
    v_dot2_f32_bf16 v145, v29, v29, v145
    v_dot2_f32_bf16 v144, v29, v150, v144
    v_dot2_f32_bf16 v145, v30, v30, v145
    v_dot2_f32_bf16 v144, v30, v150, v144
    v_dot2_f32_bf16 v145, v31, v31, v145
    v_dot2_f32_bf16 v144, v31, v150, v144
    ds_read_b128 v[28:31], v9 offset:0
    v_dot2_f32_bf16 v145, v32, v32, v145
    ds_read_b64_tr_b16 v[64:65], v17 offset:0
    v_dot2_f32_bf16 v144, v32, v150, v144
    ds_read_b64_tr_b16 v[66:67], v17 offset:768
    v_dot2_f32_bf16 v145, v33, v33, v145
    ds_read_b128 v[60:63], v13 offset:0
    v_dot2_f32_bf16 v144, v33, v150, v144
    ds_read_b64_tr_b16 v[76:77], v21 offset:0
    v_dot2_f32_bf16 v145, v34, v34, v145
    ds_read_b64_tr_b16 v[78:79], v21 offset:512
    v_dot2_f32_bf16 v144, v34, v150, v144
    ds_read_b64_tr_b16 v[68:69], v17 offset:64
    v_dot2_f32_bf16 v145, v35, v35, v145
    ds_read_b64_tr_b16 v[70:71], v17 offset:832
    v_dot2_f32_bf16 v144, v35, v150, v144
    ds_read_b64_tr_b16 v[72:73], v17 offset:128
    v_dot2_f32_bf16 v145, v36, v36, v145
    ds_read_b64_tr_b16 v[74:75], v17 offset:896
    v_dot2_f32_bf16 v144, v36, v150, v144
    v_dot2_f32_bf16 v145, v37, v37, v145
    v_dot2_f32_bf16 v144, v37, v150, v144
    v_dot2_f32_bf16 v145, v38, v38, v145
    v_dot2_f32_bf16 v144, v38, v150, v144
    v_dot2_f32_bf16 v145, v39, v39, v145
    v_dot2_f32_bf16 v144, v39, v150, v144
    s_waitcnt lgkmcnt(15)
    v_mfma_f32_32x32x16_bf16 v[80:95], v[44:47], v[24:27], v[80:95]
    ds_read_b128 v[32:35], v10 offset:0
    s_waitcnt lgkmcnt(15)
    v_mfma_f32_32x32x16_bf16 v[128:143], v[56:59], v[40:43], v[128:143]
    ds_read_b128 v[36:39], v11 offset:0
    s_waitcnt lgkmcnt(14)
    v_mfma_f32_32x32x16_bf16 v[96:111], v[48:51], v[24:27], v[96:111]
    s_waitcnt lgkmcnt(12)
    v_mfma_f32_32x32x16_bf16 v[112:127], v[52:55], v[24:27], v[112:127]
    s_waitcnt lgkmcnt(9)
    v_mfma_f32_32x32x16_bf16 v[80:95], v[64:67], v[28:31], v[80:95]
    ds_read_b64_tr_b16 v[44:45], v18 offset:0
    ds_read_b64_tr_b16 v[46:47], v18 offset:768
    ds_read_b128 v[40:43], v14 offset:0
    s_waitcnt lgkmcnt(9)
    v_mfma_f32_32x32x16_bf16 v[128:143], v[76:79], v[60:63], v[128:143]
    ds_read_b64_tr_b16 v[56:57], v22 offset:0
    ds_read_b64_tr_b16 v[58:59], v22 offset:512
    ds_read_b64_tr_b16 v[48:49], v18 offset:64
    s_waitcnt lgkmcnt(10)
    v_mfma_f32_32x32x16_bf16 v[96:111], v[68:71], v[28:31], v[96:111]
    ds_read_b64_tr_b16 v[50:51], v18 offset:832
    ds_read_b64_tr_b16 v[52:53], v18 offset:128
    ds_read_b64_tr_b16 v[54:55], v18 offset:896
    s_waitcnt lgkmcnt(11)
    v_mfma_f32_32x32x16_bf16 v[112:127], v[72:75], v[28:31], v[112:127]
    s_waitcnt lgkmcnt(7)
    v_mfma_f32_32x32x16_bf16 v[80:95], v[44:47], v[32:35], v[80:95]
    ds_read_b64_tr_b16 v[64:65], v19 offset:0
    ds_read_b64_tr_b16 v[66:67], v19 offset:768
    ds_read_b128 v[60:63], v15 offset:0
    s_waitcnt lgkmcnt(7)
    v_mfma_f32_32x32x16_bf16 v[128:143], v[56:59], v[40:43], v[128:143]
    ds_read_b64_tr_b16 v[76:77], v23 offset:0
    ds_read_b64_tr_b16 v[78:79], v23 offset:512
    ds_read_b64_tr_b16 v[68:69], v19 offset:64
    s_waitcnt lgkmcnt(8)
    v_mfma_f32_32x32x16_bf16 v[96:111], v[48:51], v[32:35], v[96:111]
    ds_read_b64_tr_b16 v[70:71], v19 offset:832
    ds_read_b64_tr_b16 v[72:73], v19 offset:128
    ds_read_b64_tr_b16 v[74:75], v19 offset:896
    s_waitcnt lgkmcnt(9)
    v_mfma_f32_32x32x16_bf16 v[112:127], v[52:55], v[32:35], v[112:127]
    s_waitcnt lgkmcnt(7)
    v_mfma_f32_32x32x16_bf16 v[80:95], v[64:67], v[36:39], v[80:95]
    s_waitcnt lgkmcnt(0)
    s_barrier
    v_mfma_f32_32x32x16_bf16 v[128:143], v[76:79], v[60:63], v[128:143]
    v_mfma_f32_32x32x16_bf16 v[96:111], v[68:71], v[36:39], v[96:111]
    v_mfma_f32_32x32x16_bf16 v[112:127], v[72:75], v[36:39], v[112:127]
    v_dot2_f32_bf16 v149, v56, v150, v149
    v_dot2_f32_bf16 v149, v57, v150, v149
    v_dot2_f32_bf16 v149, v58, v150, v149
    v_dot2_f32_bf16 v149, v59, v150, v149
    v_dot2_f32_bf16 v145, v24, v24, v145
    v_dot2_f32_bf16 v144, v24, v150, v144
    v_dot2_f32_bf16 v145, v25, v25, v145
    v_dot2_f32_bf16 v144, v25, v150, v144
    v_dot2_f32_bf16 v145, v26, v26, v145
    v_dot2_f32_bf16 v144, v26, v150, v144
    v_dot2_f32_bf16 v145, v27, v27, v145
    v_dot2_f32_bf16 v144, v27, v150, v144
    ds_read_b128 v[24:27], v8 offset:36864
    v_dot2_f32_bf16 v146, v64, v150, v146
    ds_read_b64_tr_b16 v[44:45], v16 offset:36864
    v_dot2_f32_bf16 v147, v68, v150, v147
    ds_read_b64_tr_b16 v[46:47], v16 offset:37632
    v_dot2_f32_bf16 v148, v72, v150, v148
    ds_read_b128 v[40:43], v12 offset:36864
    v_dot2_f32_bf16 v146, v65, v150, v146
    ds_read_b64_tr_b16 v[56:57], v20 offset:36864
    v_dot2_f32_bf16 v147, v69, v150, v147
    ds_read_b64_tr_b16 v[58:59], v20 offset:37376
    v_dot2_f32_bf16 v148, v73, v150, v148
    ds_read_b64_tr_b16 v[48:49], v16 offset:36928
    v_dot2_f32_bf16 v146, v66, v150, v146
    ds_read_b64_tr_b16 v[50:51], v16 offset:37696
    v_dot2_f32_bf16 v147, v70, v150, v147
    ds_read_b64_tr_b16 v[52:53], v16 offset:36992
    v_dot2_f32_bf16 v148, v74, v150, v148
    ds_read_b64_tr_b16 v[54:55], v16 offset:37760
    v_dot2_f32_bf16 v146, v67, v150, v146
    v_dot2_f32_bf16 v147, v71, v150, v147
    v_dot2_f32_bf16 v148, v75, v150, v148
    v_dot2_f32_bf16 v149, v76, v150, v149
    v_dot2_f32_bf16 v149, v77, v150, v149
    v_dot2_f32_bf16 v149, v78, v150, v149
    v_dot2_f32_bf16 v149, v79, v150, v149
    v_dot2_f32_bf16 v145, v28, v28, v145
    v_dot2_f32_bf16 v144, v28, v150, v144
    v_dot2_f32_bf16 v145, v29, v29, v145
    v_dot2_f32_bf16 v144, v29, v150, v144
    v_dot2_f32_bf16 v145, v30, v30, v145
    v_dot2_f32_bf16 v144, v30, v150, v144
    v_dot2_f32_bf16 v145, v31, v31, v145
    v_dot2_f32_bf16 v144, v31, v150, v144
    ds_read_b128 v[28:31], v9 offset:36864
    v_dot2_f32_bf16 v145, v32, v32, v145
    ds_read_b64_tr_b16 v[64:65], v17 offset:36864
    v_dot2_f32_bf16 v144, v32, v150, v144
    ds_read_b64_tr_b16 v[66:67], v17 offset:37632
    v_dot2_f32_bf16 v145, v33, v33, v145
    ds_read_b128 v[60:63], v13 offset:36864
    v_dot2_f32_bf16 v144, v33, v150, v144
    ds_read_b64_tr_b16 v[76:77], v21 offset:36864
    v_dot2_f32_bf16 v145, v34, v34, v145
    ds_read_b64_tr_b16 v[78:79], v21 offset:37376
    v_dot2_f32_bf16 v144, v34, v150, v144
    ds_read_b64_tr_b16 v[68:69], v17 offset:36928
    v_dot2_f32_bf16 v145, v35, v35, v145
    ds_read_b64_tr_b16 v[70:71], v17 offset:37696
    v_dot2_f32_bf16 v144, v35, v150, v144
    ds_read_b64_tr_b16 v[72:73], v17 offset:36992
    v_dot2_f32_bf16 v145, v36, v36, v145
    ds_read_b64_tr_b16 v[74:75], v17 offset:37760
    v_dot2_f32_bf16 v144, v36, v150, v144
    v_dot2_f32_bf16 v145, v37, v37, v145
    v_dot2_f32_bf16 v144, v37, v150, v144
    v_dot2_f32_bf16 v145, v38, v38, v145
    v_dot2_f32_bf16 v144, v38, v150, v144
    v_dot2_f32_bf16 v145, v39, v39, v145
    v_dot2_f32_bf16 v144, v39, v150, v144
    s_waitcnt lgkmcnt(15)
    v_mfma_f32_32x32x16_bf16 v[80:95], v[44:47], v[24:27], v[80:95]
    ds_read_b128 v[32:35], v10 offset:36864
    s_waitcnt lgkmcnt(15)
    v_mfma_f32_32x32x16_bf16 v[128:143], v[56:59], v[40:43], v[128:143]
    ds_read_b128 v[36:39], v11 offset:36864
    s_waitcnt lgkmcnt(14)
    v_mfma_f32_32x32x16_bf16 v[96:111], v[48:51], v[24:27], v[96:111]
    s_waitcnt lgkmcnt(12)
    v_mfma_f32_32x32x16_bf16 v[112:127], v[52:55], v[24:27], v[112:127]
    s_waitcnt lgkmcnt(9)
    v_mfma_f32_32x32x16_bf16 v[80:95], v[64:67], v[28:31], v[80:95]
    ds_read_b64_tr_b16 v[44:45], v18 offset:36864
    ds_read_b64_tr_b16 v[46:47], v18 offset:37632
    ds_read_b128 v[40:43], v14 offset:36864
    s_waitcnt lgkmcnt(9)
    v_mfma_f32_32x32x16_bf16 v[128:143], v[76:79], v[60:63], v[128:143]
    ds_read_b64_tr_b16 v[56:57], v22 offset:36864
    ds_read_b64_tr_b16 v[58:59], v22 offset:37376
    ds_read_b64_tr_b16 v[48:49], v18 offset:36928
    s_waitcnt lgkmcnt(10)
    v_mfma_f32_32x32x16_bf16 v[96:111], v[68:71], v[28:31], v[96:111]
    ds_read_b64_tr_b16 v[50:51], v18 offset:37696
    ds_read_b64_tr_b16 v[52:53], v18 offset:36992
    ds_read_b64_tr_b16 v[54:55], v18 offset:37760
    s_waitcnt lgkmcnt(11)
    v_mfma_f32_32x32x16_bf16 v[112:127], v[72:75], v[28:31], v[112:127]
    s_waitcnt lgkmcnt(7)
    v_mfma_f32_32x32x16_bf16 v[80:95], v[44:47], v[32:35], v[80:95]
    ds_read_b64_tr_b16 v[64:65], v19 offset:36864
    ds_read_b64_tr_b16 v[66:67], v19 offset:37632
    ds_read_b128 v[60:63], v15 offset:36864
    s_waitcnt lgkmcnt(7)
    v_mfma_f32_32x32x16_bf16 v[128:143], v[56:59], v[40:43], v[128:143]
    ds_read_b64_tr_b16 v[76:77], v23 offset:36864
    ds_read_b64_tr_b16 v[78:79], v23 offset:37376
    ds_read_b64_tr_b16 v[68:69], v19 offset:36928
    s_waitcnt lgkmcnt(8)
    v_mfma_f32_32x32x16_bf16 v[96:111], v[48:51], v[32:35], v[96:111]
    ds_read_b64_tr_b16 v[70:71], v19 offset:37696
    ds_read_b64_tr_b16 v[72:73], v19 offset:36992
    ds_read_b64_tr_b16 v[74:75], v19 offset:37760
    s_waitcnt lgkmcnt(9)
    v_mfma_f32_32x32x16_bf16 v[112:127], v[52:55], v[32:35], v[112:127]
    s_waitcnt lgkmcnt(7)
    v_mfma_f32_32x32x16_bf16 v[80:95], v[64:67], v[36:39], v[80:95]
    s_waitcnt lgkmcnt(4)
    v_mfma_f32_32x32x16_bf16 v[128:143], v[76:79], v[60:63], v[128:143]
    s_waitcnt lgkmcnt(2)
    v_mfma_f32_32x32x16_bf16 v[96:111], v[68:71], v[36:39], v[96:111]
    s_waitcnt lgkmcnt(0)
    v_mfma_f32_32x32x16_bf16 v[112:127], v[72:75], v[36:39], v[112:127]
    v_dot2_f32_bf16 v149, v56, v150, v149
    v_dot2_f32_bf16 v149, v57, v150, v149
    v_dot2_f32_bf16 v149, v58, v150, v149
    v_dot2_f32_bf16 v149, v59, v150, v149
    v_dot2_f32_bf16 v145, v24, v24, v145
    v_dot2_f32_bf16 v144, v24, v150, v144
    v_dot2_f32_bf16 v145, v25, v25, v145
    v_dot2_f32_bf16 v144, v25, v150, v144
    v_dot2_f32_bf16 v145, v26, v26, v145
    v_dot2_f32_bf16 v144, v26, v150, v144
    v_dot2_f32_bf16 v145, v27, v27, v145
    v_dot2_f32_bf16 v144, v27, v150, v144
    v_dot2_f32_bf16 v146, v64, v150, v146
    v_dot2_f32_bf16 v147, v68, v150, v147
    v_dot2_f32_bf16 v148, v72, v150, v148
    v_dot2_f32_bf16 v146, v65, v150, v146
    v_dot2_f32_bf16 v147, v69, v150, v147
    v_dot2_f32_bf16 v148, v73, v150, v148
    v_dot2_f32_bf16 v146, v66, v150, v146
    v_dot2_f32_bf16 v147, v70, v150, v147
    v_dot2_f32_bf16 v148, v74, v150, v148
    v_dot2_f32_bf16 v146, v67, v150, v146
    v_dot2_f32_bf16 v147, v71, v150, v147
    v_dot2_f32_bf16 v148, v75, v150, v148
    v_dot2_f32_bf16 v149, v76, v150, v149
    v_dot2_f32_bf16 v149, v77, v150, v149
    v_dot2_f32_bf16 v149, v78, v150, v149
    v_dot2_f32_bf16 v149, v79, v150, v149
    v_dot2_f32_bf16 v145, v28, v28, v145
    v_dot2_f32_bf16 v144, v28, v150, v144
    v_dot2_f32_bf16 v145, v29, v29, v145
    v_dot2_f32_bf16 v144, v29, v150, v144
    v_dot2_f32_bf16 v145, v30, v30, v145
    v_dot2_f32_bf16 v144, v30, v150, v144
    v_dot2_f32_bf16 v145, v31, v31, v145
    v_dot2_f32_bf16 v144, v31, v150, v144
    v_dot2_f32_bf16 v145, v32, v32, v145
    v_dot2_f32_bf16 v144, v32, v150, v144
    v_dot2_f32_bf16 v145, v33, v33, v145
    v_dot2_f32_bf16 v144, v33, v150, v144
    v_dot2_f32_bf16 v145, v34, v34, v145
    v_dot2_f32_bf16 v144, v34, v150, v144
    v_dot2_f32_bf16 v145, v35, v35, v145
    v_dot2_f32_bf16 v144, v35, v150, v144
    v_dot2_f32_bf16 v145, v36, v36, v145
    v_dot2_f32_bf16 v144, v36, v150, v144
    v_dot2_f32_bf16 v145, v37, v37, v145
    v_dot2_f32_bf16 v144, v37, v150, v144
    v_dot2_f32_bf16 v145, v38, v38, v145
    v_dot2_f32_bf16 v144, v38, v150, v144
    v_dot2_f32_bf16 v145, v39, v39, v145
    v_dot2_f32_bf16 v144, v39, v150, v144
    s_nop 3
    v_mov_b32 v26, v144
    v_mov_b32 v27, v145
    s_nop 1
    v_permlane32_swap_b32 v144, v26
    v_permlane32_swap_b32 v145, v27
    s_nop 1
    v_add_f32 v144, v144, v26
    v_add_f32 v145, v145, v27
    v_mul_f32 v24, 0x3b000000, v144
    v_mul_f32 v26, v24, v24
    v_mul_f32 v27, 0x3b000000, v145
    v_sub_f32 v27, v27, v26
    v_max_f32 v27, 0, v27
    v_cvt_pk_bf16_f32 v24, v24, v24
    v_and_b32 v24, 0xffff0000, v24
    v_cvt_pk_bf16_f32 v27, v27, v27
    v_and_b32 v27, 0xffff0000, v27
    v_add_f32 v27, 0x3727c5ac, v27
    v_cvt_pk_bf16_f32 v27, v27, v27
    v_and_b32 v27, 0xffff0000, v27
    v_sqrt_f32 v25, v27
    s_nop 0
    v_cvt_pk_bf16_f32 v25, v25, v25
    v_and_b32 v25, 0xffff0000, v25
    v_mov_b32 v28, v146
    v_mov_b32 v29, v147
    v_mov_b32 v30, v148
    v_mov_b32 v31, v149
    s_nop 1
    v_permlane32_swap_b32 v146, v28
    v_permlane32_swap_b32 v147, v29
    v_permlane32_swap_b32 v148, v30
    v_permlane32_swap_b32 v149, v31
    s_nop 1
    v_add_f32 v28, v146, v28
    v_add_f32 v29, v147, v29
    v_add_f32 v30, v148, v30
    v_add_f32 v31, v149, v31
    v_lshlrev_b32 v32, 3, v2
    v_lshlrev_b32 v33, 4, v2
    s_lshl_b32 s13, s12, 9
    s_add_u32 s13, s13, 159744
    v_add_u32 v34, s13, v32
    s_lshl_b32 s13, s23, 9
    s_add_u32 s13, s13, 159744
    v_add_u32 v35, s13, v32
    s_lshl_b32 s13, s12, 10
    s_add_u32 s13, s13, 155648
    v_add_u32 v36, s13, v33
    ds_write_b64 v34, v[24:25]
    ds_write_b128 v36, v[28:31]
    v_xor_b32 v37, 0x400, v36
    v_xor_b32 v38, 0x800, v36
    v_xor_b32 v39, 0xc00, v36
    s_waitcnt lgkmcnt(0)
    s_barrier

    ds_read_b64 v[26:27], v35
    ds_read_b128 v[40:43], v37
    ds_read_b128 v[44:47], v38
    ds_read_b128 v[48:51], v39

    v_sub_f32 v32, 0, v24
    v_cvt_pk_bf16_f32 v52, v32, v32
    v_cvt_pk_bf16_f32 v53, v32, v25
    v_cndmask_b32 v52, 0, v52, s[56:57]
    v_cndmask_b32 v53, 0, v53, s[56:57]
    v_mov_b32 v54, 0
    v_mov_b32 v55, 0
    v_rcp_f32 v34, v25
    s_waitcnt lgkmcnt(0)
    v_add_f32 v31, v31, v43
    v_add_f32 v28, v28, v40
    v_add_f32 v44, v44, v48
    v_add_f32 v28, v28, v44
    v_add_f32 v29, v29, v41
    v_add_f32 v45, v45, v49
    v_add_f32 v29, v29, v45
    v_add_f32 v30, v30, v42
    v_add_f32 v46, v46, v50
    v_add_f32 v30, v30, v46
    v_sub_f32 v32, 0, v26
    v_cvt_pk_bf16_f32 v56, v32, v32
    v_cvt_pk_bf16_f32 v57, v32, v27
    v_cndmask_b32 v56, 0, v56, s[56:57]
    v_cndmask_b32 v57, 0, v57, s[56:57]
    v_mov_b32 v58, 0
    v_mov_b32 v59, 0
    v_cvt_pk_bf16_f32 v32, v31, v31
    v_and_b32 v32, 0xffff0000, v32
    v_sub_f32 v31, v31, v32
    v_cvt_pk_bf16_f32 v33, v31, v31
    v_and_b32 v33, 0xffff0000, v33
    v_sub_f32 v31, v31, v33
    v_cvt_pk_bf16_f32 v60, v32, v33
    v_cvt_pk_bf16_f32 v61, v31, v31
    v_and_b32 v61, 0xffff, v61
    v_mov_b32 v62, 0
    v_mov_b32 v63, 0
    v_rcp_f32 v36, v27
    s_nop 0
    v_mfma_f32_32x32x16_bf16 v[128:143], v[60:63], v[56:59], v[128:143]
    s_waitcnt vmcnt(0)
    v_cvt_pk_bf16_f32 v32, v28, v28
    v_and_b32 v32, 0xffff0000, v32
    v_sub_f32 v28, v28, v32
    v_cvt_pk_bf16_f32 v33, v28, v28
    v_and_b32 v33, 0xffff0000, v33
    v_sub_f32 v28, v28, v33
    v_cvt_pk_bf16_f32 v64, v32, v33
    v_cvt_pk_bf16_f32 v65, v28, v28
    v_and_b32 v65, 0xffff, v65
    v_lshl_or_b32 v65, v151, 16, v65
    v_mov_b32 v66, 0
    v_mov_b32 v67, 0
    s_nop 1
    v_mfma_f32_32x32x16_bf16 v[80:95], v[64:67], v[52:55], v[80:95]
    v_cvt_pk_bf16_f32 v32, v29, v29
    v_and_b32 v32, 0xffff0000, v32
    v_sub_f32 v29, v29, v32
    v_cvt_pk_bf16_f32 v33, v29, v29
    v_and_b32 v33, 0xffff0000, v33
    v_sub_f32 v29, v29, v33
    v_cvt_pk_bf16_f32 v68, v32, v33
    v_cvt_pk_bf16_f32 v69, v29, v29
    v_and_b32 v69, 0xffff, v69
    v_lshl_or_b32 v69, v152, 16, v69
    v_mov_b32 v70, 0
    v_mov_b32 v71, 0
    s_nop 1
    v_mfma_f32_32x32x16_bf16 v[96:111], v[68:71], v[52:55], v[96:111]
    v_cvt_pk_bf16_f32 v32, v30, v30
    v_and_b32 v32, 0xffff0000, v32
    v_sub_f32 v30, v30, v32
    v_cvt_pk_bf16_f32 v33, v30, v30
    v_and_b32 v33, 0xffff0000, v33
    v_sub_f32 v30, v30, v33
    v_cvt_pk_bf16_f32 v72, v32, v33
    v_cvt_pk_bf16_f32 v73, v30, v30
    v_and_b32 v73, 0xffff, v73
    v_lshl_or_b32 v73, v153, 16, v73
    v_mov_b32 v74, 0
    v_mov_b32 v75, 0
    s_nop 1
    v_mfma_f32_32x32x16_bf16 v[112:127], v[72:75], v[52:55], v[112:127]
    v_mul_f32 v36, 0x3eb8aa3b, v36
    s_lshl_b32 s13, s12, 11
    s_add_u32 s13, s13, 147456
    v_lshlrev_b32 v33, 4, v2
    v_add_u32 v38, s13, v33
    v_pk_mul_f32 v[128:129], v[128:129], v[36:37] op_sel_hi:[1,0]
    v_pk_mul_f32 v[130:131], v[130:131], v[36:37] op_sel_hi:[1,0]
    v_pk_mul_f32 v[132:133], v[132:133], v[36:37] op_sel_hi:[1,0]
    v_pk_mul_f32 v[134:135], v[134:135], v[36:37] op_sel_hi:[1,0]
    v_pk_mul_f32 v[136:137], v[136:137], v[36:37] op_sel_hi:[1,0]
    v_pk_mul_f32 v[138:139], v[138:139], v[36:37] op_sel_hi:[1,0]
    v_pk_mul_f32 v[140:141], v[140:141], v[36:37] op_sel_hi:[1,0]
    v_pk_mul_f32 v[142:143], v[142:143], v[36:37] op_sel_hi:[1,0]
    v_cvt_pk_bf16_f32 v40, v128, v129
    v_cvt_pk_bf16_f32 v41, v130, v131
    v_cvt_pk_bf16_f32 v42, v132, v133
    v_cvt_pk_bf16_f32 v43, v134, v135
    v_cvt_pk_bf16_f32 v44, v136, v137
    v_cvt_pk_bf16_f32 v45, v138, v139
    v_cvt_pk_bf16_f32 v46, v140, v141
    v_cvt_pk_bf16_f32 v47, v142, v143
    ds_write_b128 v38, v[40:43]
    ds_write_b128 v38, v[44:47] offset:1024
    v_mul_f32 v56, 0xc0135761, v34
    v_mul_f32 v52, v34, v34
    v_mul_f32 v52, v52, v34
    v_mul_f32 v52, 0xbdd2d3e8, v52
    v_mov_b32 v60, v25
    s_lshl_b32 s13, s20, 2
    s_add_u32 s13, s13, s12
    s_mul_i32 s13, s13, 86
    s_mul_i32 s59, s21, 6
    s_add_u32 s13, s13, s59
    s_lshl_b32 s13, s13, 10
    s_add_u32 s60, s13, 4325376
    s_cmp_eq_u32 s21, 14
    s_cselect_b32 s59, 0x10000000, 0
    s_add_u32 s61, s60, s59

    v_pk_mul_f32 v[64:65], v[80:81], v[80:81]
    v_pk_mul_f32 v[66:67], v[82:83], v[82:83]
    v_pk_mul_f32 v[68:69], v[84:85], v[84:85]
    v_pk_mul_f32 v[70:71], v[86:87], v[86:87]
    v_pk_fma_f32 v[64:65], v[64:65], v[52:53], v[56:57] op_sel_hi:[1,0,0]
    v_pk_fma_f32 v[66:67], v[66:67], v[52:53], v[56:57] op_sel_hi:[1,0,0]
    v_pk_fma_f32 v[68:69], v[68:69], v[52:53], v[56:57] op_sel_hi:[1,0,0]
    v_pk_fma_f32 v[70:71], v[70:71], v[52:53], v[56:57] op_sel_hi:[1,0,0]
    v_pk_mul_f32 v[64:65], v[64:65], v[80:81]
    v_pk_mul_f32 v[66:67], v[66:67], v[82:83]
    v_pk_mul_f32 v[68:69], v[68:69], v[84:85]
    v_pk_mul_f32 v[70:71], v[70:71], v[86:87]
    v_exp_f32 v64, v64
    v_exp_f32 v65, v65
    v_exp_f32 v66, v66
    v_exp_f32 v67, v67
    v_exp_f32 v68, v68
    v_exp_f32 v69, v69
    v_exp_f32 v70, v70
    v_exp_f32 v71, v71
    v_pk_fma_f32 v[64:65], v[64:65], v[60:61], v[60:61] op_sel_hi:[1,0,0]
    v_pk_fma_f32 v[66:67], v[66:67], v[60:61], v[60:61] op_sel_hi:[1,0,0]
    v_pk_fma_f32 v[68:69], v[68:69], v[60:61], v[60:61] op_sel_hi:[1,0,0]
    v_pk_fma_f32 v[70:71], v[70:71], v[60:61], v[60:61] op_sel_hi:[1,0,0]
    v_rcp_f32 v64, v64
    v_rcp_f32 v65, v65
    v_rcp_f32 v66, v66
    v_rcp_f32 v67, v67
    v_rcp_f32 v68, v68
    v_rcp_f32 v69, v69
    v_rcp_f32 v70, v70
    v_rcp_f32 v71, v71
    v_pk_mul_f32 v[64:65], v[64:65], v[80:81]
    v_pk_mul_f32 v[66:67], v[66:67], v[82:83]
    v_pk_mul_f32 v[68:69], v[68:69], v[84:85]
    v_pk_mul_f32 v[70:71], v[70:71], v[86:87]
    v_cvt_pk_bf16_f32 v80, v64, v65
    v_cvt_pk_bf16_f32 v81, v66, v67
    v_cvt_pk_bf16_f32 v82, v68, v69
    v_cvt_pk_bf16_f32 v83, v70, v71
    buffer_store_dwordx4 v[80:83], v33, s[8:11], s60 offen offset:0 sc1
    v_pk_mul_f32 v[64:65], v[88:89], v[88:89]
    v_pk_mul_f32 v[66:67], v[90:91], v[90:91]
    v_pk_mul_f32 v[68:69], v[92:93], v[92:93]
    v_pk_mul_f32 v[70:71], v[94:95], v[94:95]
    v_pk_fma_f32 v[64:65], v[64:65], v[52:53], v[56:57] op_sel_hi:[1,0,0]
    v_pk_fma_f32 v[66:67], v[66:67], v[52:53], v[56:57] op_sel_hi:[1,0,0]
    v_pk_fma_f32 v[68:69], v[68:69], v[52:53], v[56:57] op_sel_hi:[1,0,0]
    v_pk_fma_f32 v[70:71], v[70:71], v[52:53], v[56:57] op_sel_hi:[1,0,0]
    v_pk_mul_f32 v[64:65], v[64:65], v[88:89]
    v_pk_mul_f32 v[66:67], v[66:67], v[90:91]
    v_pk_mul_f32 v[68:69], v[68:69], v[92:93]
    v_pk_mul_f32 v[70:71], v[70:71], v[94:95]
    v_exp_f32 v64, v64
    v_exp_f32 v65, v65
    v_exp_f32 v66, v66
    v_exp_f32 v67, v67
    v_exp_f32 v68, v68
    v_exp_f32 v69, v69
    v_exp_f32 v70, v70
    v_exp_f32 v71, v71
    v_pk_fma_f32 v[64:65], v[64:65], v[60:61], v[60:61] op_sel_hi:[1,0,0]
    v_pk_fma_f32 v[66:67], v[66:67], v[60:61], v[60:61] op_sel_hi:[1,0,0]
    v_pk_fma_f32 v[68:69], v[68:69], v[60:61], v[60:61] op_sel_hi:[1,0,0]
    v_pk_fma_f32 v[70:71], v[70:71], v[60:61], v[60:61] op_sel_hi:[1,0,0]
    v_rcp_f32 v64, v64
    v_rcp_f32 v65, v65
    v_rcp_f32 v66, v66
    v_rcp_f32 v67, v67
    v_rcp_f32 v68, v68
    v_rcp_f32 v69, v69
    v_rcp_f32 v70, v70
    v_rcp_f32 v71, v71
    v_pk_mul_f32 v[64:65], v[64:65], v[88:89]
    v_pk_mul_f32 v[66:67], v[66:67], v[90:91]
    v_pk_mul_f32 v[68:69], v[68:69], v[92:93]
    v_pk_mul_f32 v[70:71], v[70:71], v[94:95]
    v_cvt_pk_bf16_f32 v88, v64, v65
    v_cvt_pk_bf16_f32 v89, v66, v67
    v_cvt_pk_bf16_f32 v90, v68, v69
    v_cvt_pk_bf16_f32 v91, v70, v71
    buffer_store_dwordx4 v[88:91], v33, s[8:11], s60 offen offset:1024 sc1
    v_pk_mul_f32 v[64:65], v[96:97], v[96:97]
    v_pk_mul_f32 v[66:67], v[98:99], v[98:99]
    v_pk_mul_f32 v[68:69], v[100:101], v[100:101]
    v_pk_mul_f32 v[70:71], v[102:103], v[102:103]
    v_pk_fma_f32 v[64:65], v[64:65], v[52:53], v[56:57] op_sel_hi:[1,0,0]
    v_pk_fma_f32 v[66:67], v[66:67], v[52:53], v[56:57] op_sel_hi:[1,0,0]
    v_pk_fma_f32 v[68:69], v[68:69], v[52:53], v[56:57] op_sel_hi:[1,0,0]
    v_pk_fma_f32 v[70:71], v[70:71], v[52:53], v[56:57] op_sel_hi:[1,0,0]
    v_pk_mul_f32 v[64:65], v[64:65], v[96:97]
    v_pk_mul_f32 v[66:67], v[66:67], v[98:99]
    v_pk_mul_f32 v[68:69], v[68:69], v[100:101]
    v_pk_mul_f32 v[70:71], v[70:71], v[102:103]
    v_exp_f32 v64, v64
    v_exp_f32 v65, v65
    v_exp_f32 v66, v66
    v_exp_f32 v67, v67
    v_exp_f32 v68, v68
    v_exp_f32 v69, v69
    v_exp_f32 v70, v70
    v_exp_f32 v71, v71
    v_pk_fma_f32 v[64:65], v[64:65], v[60:61], v[60:61] op_sel_hi:[1,0,0]
    v_pk_fma_f32 v[66:67], v[66:67], v[60:61], v[60:61] op_sel_hi:[1,0,0]
    v_pk_fma_f32 v[68:69], v[68:69], v[60:61], v[60:61] op_sel_hi:[1,0,0]
    v_pk_fma_f32 v[70:71], v[70:71], v[60:61], v[60:61] op_sel_hi:[1,0,0]
    v_rcp_f32 v64, v64
    v_rcp_f32 v65, v65
    v_rcp_f32 v66, v66
    v_rcp_f32 v67, v67
    v_rcp_f32 v68, v68
    v_rcp_f32 v69, v69
    v_rcp_f32 v70, v70
    v_rcp_f32 v71, v71
    v_pk_mul_f32 v[64:65], v[64:65], v[96:97]
    v_pk_mul_f32 v[66:67], v[66:67], v[98:99]
    v_pk_mul_f32 v[68:69], v[68:69], v[100:101]
    v_pk_mul_f32 v[70:71], v[70:71], v[102:103]
    v_cvt_pk_bf16_f32 v96, v64, v65
    v_cvt_pk_bf16_f32 v97, v66, v67
    v_cvt_pk_bf16_f32 v98, v68, v69
    v_cvt_pk_bf16_f32 v99, v70, v71
    buffer_store_dwordx4 v[96:99], v33, s[8:11], s61 offen offset:2048 sc1
    v_pk_mul_f32 v[64:65], v[104:105], v[104:105]
    v_pk_mul_f32 v[66:67], v[106:107], v[106:107]
    v_pk_mul_f32 v[68:69], v[108:109], v[108:109]
    v_pk_mul_f32 v[70:71], v[110:111], v[110:111]
    v_pk_fma_f32 v[64:65], v[64:65], v[52:53], v[56:57] op_sel_hi:[1,0,0]
    v_pk_fma_f32 v[66:67], v[66:67], v[52:53], v[56:57] op_sel_hi:[1,0,0]
    v_pk_fma_f32 v[68:69], v[68:69], v[52:53], v[56:57] op_sel_hi:[1,0,0]
    v_pk_fma_f32 v[70:71], v[70:71], v[52:53], v[56:57] op_sel_hi:[1,0,0]
    v_pk_mul_f32 v[64:65], v[64:65], v[104:105]
    v_pk_mul_f32 v[66:67], v[66:67], v[106:107]
    v_pk_mul_f32 v[68:69], v[68:69], v[108:109]
    v_pk_mul_f32 v[70:71], v[70:71], v[110:111]
    v_exp_f32 v64, v64
    v_exp_f32 v65, v65
    v_exp_f32 v66, v66
    v_exp_f32 v67, v67
    v_exp_f32 v68, v68
    v_exp_f32 v69, v69
    v_exp_f32 v70, v70
    v_exp_f32 v71, v71
    v_pk_fma_f32 v[64:65], v[64:65], v[60:61], v[60:61] op_sel_hi:[1,0,0]
    v_pk_fma_f32 v[66:67], v[66:67], v[60:61], v[60:61] op_sel_hi:[1,0,0]
    v_pk_fma_f32 v[68:69], v[68:69], v[60:61], v[60:61] op_sel_hi:[1,0,0]
    v_pk_fma_f32 v[70:71], v[70:71], v[60:61], v[60:61] op_sel_hi:[1,0,0]
    v_rcp_f32 v64, v64
    v_rcp_f32 v65, v65
    v_rcp_f32 v66, v66
    v_rcp_f32 v67, v67
    v_rcp_f32 v68, v68
    v_rcp_f32 v69, v69
    v_rcp_f32 v70, v70
    v_rcp_f32 v71, v71
    v_pk_mul_f32 v[64:65], v[64:65], v[104:105]
    v_pk_mul_f32 v[66:67], v[66:67], v[106:107]
    v_pk_mul_f32 v[68:69], v[68:69], v[108:109]
    v_pk_mul_f32 v[70:71], v[70:71], v[110:111]
    v_cvt_pk_bf16_f32 v104, v64, v65
    v_cvt_pk_bf16_f32 v105, v66, v67
    v_cvt_pk_bf16_f32 v106, v68, v69
    v_cvt_pk_bf16_f32 v107, v70, v71
    buffer_store_dwordx4 v[104:107], v33, s[8:11], s61 offen offset:3072 sc1
    v_pk_mul_f32 v[64:65], v[112:113], v[112:113]
    v_pk_mul_f32 v[66:67], v[114:115], v[114:115]
    v_pk_mul_f32 v[68:69], v[116:117], v[116:117]
    v_pk_mul_f32 v[70:71], v[118:119], v[118:119]
    v_pk_fma_f32 v[64:65], v[64:65], v[52:53], v[56:57] op_sel_hi:[1,0,0]
    v_pk_fma_f32 v[66:67], v[66:67], v[52:53], v[56:57] op_sel_hi:[1,0,0]
    v_pk_fma_f32 v[68:69], v[68:69], v[52:53], v[56:57] op_sel_hi:[1,0,0]
    v_pk_fma_f32 v[70:71], v[70:71], v[52:53], v[56:57] op_sel_hi:[1,0,0]
    v_pk_mul_f32 v[64:65], v[64:65], v[112:113]
    v_pk_mul_f32 v[66:67], v[66:67], v[114:115]
    v_pk_mul_f32 v[68:69], v[68:69], v[116:117]
    v_pk_mul_f32 v[70:71], v[70:71], v[118:119]
    v_exp_f32 v64, v64
    v_exp_f32 v65, v65
    v_exp_f32 v66, v66
    v_exp_f32 v67, v67
    v_exp_f32 v68, v68
    v_exp_f32 v69, v69
    v_exp_f32 v70, v70
    v_exp_f32 v71, v71
    v_pk_fma_f32 v[64:65], v[64:65], v[60:61], v[60:61] op_sel_hi:[1,0,0]
    v_pk_fma_f32 v[66:67], v[66:67], v[60:61], v[60:61] op_sel_hi:[1,0,0]
    v_pk_fma_f32 v[68:69], v[68:69], v[60:61], v[60:61] op_sel_hi:[1,0,0]
    v_pk_fma_f32 v[70:71], v[70:71], v[60:61], v[60:61] op_sel_hi:[1,0,0]
    v_rcp_f32 v64, v64
    v_rcp_f32 v65, v65
    v_rcp_f32 v66, v66
    v_rcp_f32 v67, v67
    v_rcp_f32 v68, v68
    v_rcp_f32 v69, v69
    v_rcp_f32 v70, v70
    v_rcp_f32 v71, v71
    v_pk_mul_f32 v[64:65], v[64:65], v[112:113]
    v_pk_mul_f32 v[66:67], v[66:67], v[114:115]
    v_pk_mul_f32 v[68:69], v[68:69], v[116:117]
    v_pk_mul_f32 v[70:71], v[70:71], v[118:119]
    v_cvt_pk_bf16_f32 v112, v64, v65
    v_cvt_pk_bf16_f32 v113, v66, v67
    v_cvt_pk_bf16_f32 v114, v68, v69
    v_cvt_pk_bf16_f32 v115, v70, v71
    s_add_u32 s61, s61, 4096
    buffer_store_dwordx4 v[112:115], v33, s[8:11], s61 offen offset:0 sc1
    v_pk_mul_f32 v[64:65], v[120:121], v[120:121]
    v_pk_mul_f32 v[66:67], v[122:123], v[122:123]
    v_pk_mul_f32 v[68:69], v[124:125], v[124:125]
    v_pk_mul_f32 v[70:71], v[126:127], v[126:127]
    v_pk_fma_f32 v[64:65], v[64:65], v[52:53], v[56:57] op_sel_hi:[1,0,0]
    v_pk_fma_f32 v[66:67], v[66:67], v[52:53], v[56:57] op_sel_hi:[1,0,0]
    v_pk_fma_f32 v[68:69], v[68:69], v[52:53], v[56:57] op_sel_hi:[1,0,0]
    v_pk_fma_f32 v[70:71], v[70:71], v[52:53], v[56:57] op_sel_hi:[1,0,0]
    v_pk_mul_f32 v[64:65], v[64:65], v[120:121]
    v_pk_mul_f32 v[66:67], v[66:67], v[122:123]
    v_pk_mul_f32 v[68:69], v[68:69], v[124:125]
    v_pk_mul_f32 v[70:71], v[70:71], v[126:127]
    v_exp_f32 v64, v64
    v_exp_f32 v65, v65
    v_exp_f32 v66, v66
    v_exp_f32 v67, v67
    v_exp_f32 v68, v68
    v_exp_f32 v69, v69
    v_exp_f32 v70, v70
    v_exp_f32 v71, v71
    v_pk_fma_f32 v[64:65], v[64:65], v[60:61], v[60:61] op_sel_hi:[1,0,0]
    v_pk_fma_f32 v[66:67], v[66:67], v[60:61], v[60:61] op_sel_hi:[1,0,0]
    v_pk_fma_f32 v[68:69], v[68:69], v[60:61], v[60:61] op_sel_hi:[1,0,0]
    v_pk_fma_f32 v[70:71], v[70:71], v[60:61], v[60:61] op_sel_hi:[1,0,0]
    v_rcp_f32 v64, v64
    v_rcp_f32 v65, v65
    v_rcp_f32 v66, v66
    v_rcp_f32 v67, v67
    v_rcp_f32 v68, v68
    v_rcp_f32 v69, v69
    v_rcp_f32 v70, v70
    v_rcp_f32 v71, v71
    v_pk_mul_f32 v[64:65], v[64:65], v[120:121]
    v_pk_mul_f32 v[66:67], v[66:67], v[122:123]
    v_pk_mul_f32 v[68:69], v[68:69], v[124:125]
    v_pk_mul_f32 v[70:71], v[70:71], v[126:127]
    v_cvt_pk_bf16_f32 v120, v64, v65
    v_cvt_pk_bf16_f32 v121, v66, v67
    v_cvt_pk_bf16_f32 v122, v68, v69
    v_cvt_pk_bf16_f32 v123, v70, v71
    buffer_store_dwordx4 v[120:123], v33, s[8:11], s61 offen offset:1024 sc1
    s_waitcnt lgkmcnt(0)
    s_barrier
    v_mov_b32 v62, 163072
    v_mov_b32 v63, 1
    v_mov_b32 v61, 0
    s_mul_i32 s13, s20, 128
    s_lshl_b32 s22, s21, 2
    s_add_u32 s13, s13, s22
    s_add_u32 s13, s13, 10825728
    s_mov_b64 exec, 1
    ds_read_b32 v64, v62 offset:80
    s_waitcnt vmcnt(0)
    ds_add_rtn_u32 v60, v62, v63 offset:76
    s_waitcnt lgkmcnt(0)
    v_readfirstlane_b32 s22, v60
    s_cmp_eq_u32 s22, 3
    s_cbranch_scc0 M_H_NF
    buffer_store_dword v64, v61, s[8:11], s13 offen sc1
M_H_NF:
    s_mov_b64 exec, -1
    s_mov_b32 s65, 1
    s_branch M_ATT
M_CKV:
    v_lshlrev_b32 v156, 5, v6
    v_lshl_add_u32 v156, v7, 11, v156
    v_lshl_add_u32 v156, v155, 3, v156
    v_add_u32 v156, 16384, v156
    s_xor_b32 s13, s22, 0
    s_lshl_b32 s13, s13, 9
    v_add_u32 v16, s13, v156
    s_xor_b32 s13, s22, 1
    s_lshl_b32 s13, s13, 9
    v_add_u32 v17, s13, v156
    s_xor_b32 s13, s22, 2
    s_lshl_b32 s13, s13, 9
    v_add_u32 v18, s13, v156
    s_xor_b32 s13, s22, 3
    s_lshl_b32 s13, s13, 9
    v_add_u32 v19, s13, v156
    s_mov_b32 s59, 0
    s_mov_b32 s60, 36864
M_CKV1:
    s_barrier
    ds_read_b128 v[24:27], v8
    ds_read_b64_tr_b16 v[40:41], v16
    ds_read_b64_tr_b16 v[42:43], v16 offset:128
    ds_read_b128 v[28:31], v9
    ds_read_b64_tr_b16 v[44:45], v17
    ds_read_b64_tr_b16 v[46:47], v17 offset:128
    ds_read_b128 v[32:35], v10
    ds_read_b64_tr_b16 v[48:49], v18
    ds_read_b64_tr_b16 v[50:51], v18 offset:128
    ds_read_b128 v[36:39], v11
    ds_read_b64_tr_b16 v[52:53], v19
    ds_read_b64_tr_b16 v[54:55], v19 offset:128
    s_waitcnt lgkmcnt(9)
    v_mfma_f32_32x32x16_bf16 v[80:95], v[40:43], v[24:27], v[80:95]
    v_mfma_f32_32x32x16_bf16 v[96:111], v[24:27], v[40:43], v[96:111]
    s_waitcnt lgkmcnt(6)
    v_mfma_f32_32x32x16_bf16 v[80:95], v[44:47], v[28:31], v[80:95]
    v_mfma_f32_32x32x16_bf16 v[96:111], v[28:31], v[44:47], v[96:111]
    s_waitcnt lgkmcnt(3)
    v_mfma_f32_32x32x16_bf16 v[80:95], v[48:51], v[32:35], v[80:95]
    v_mfma_f32_32x32x16_bf16 v[96:111], v[32:35], v[48:51], v[96:111]
    s_waitcnt lgkmcnt(0)
    v_mfma_f32_32x32x16_bf16 v[80:95], v[52:55], v[36:39], v[80:95]
    v_mfma_f32_32x32x16_bf16 v[96:111], v[36:39], v[52:55], v[96:111]
    s_add_u32 s59, s59, 1
    s_and_b32 s13, s59, 3
    s_cmp_eq_u32 s13, 0
    s_cselect_b32 s13, -110592, s60
    v_add_u32 v8, s13, v8
    v_add_u32 v9, s13, v9
    v_add_u32 v10, s13, v10
    v_add_u32 v11, s13, v11
    v_add_u32 v16, s13, v16
    v_add_u32 v17, s13, v17
    v_add_u32 v18, s13, v18
    v_add_u32 v19, s13, v19
    v_dot2_f32_bf16 v145, v24, v24, v145
    v_dot2_f32_bf16 v144, v24, v150, v144
    v_dot2_f32_bf16 v146, v40, v150, v146
    v_dot2_f32_bf16 v145, v25, v25, v145
    v_dot2_f32_bf16 v144, v25, v150, v144
    v_dot2_f32_bf16 v146, v41, v150, v146
    v_dot2_f32_bf16 v145, v26, v26, v145
    v_dot2_f32_bf16 v144, v26, v150, v144
    v_dot2_f32_bf16 v146, v42, v150, v146
    v_dot2_f32_bf16 v145, v27, v27, v145
    v_dot2_f32_bf16 v144, v27, v150, v144
    v_dot2_f32_bf16 v146, v43, v150, v146
    v_dot2_f32_bf16 v145, v28, v28, v145
    v_dot2_f32_bf16 v144, v28, v150, v144
    v_dot2_f32_bf16 v146, v44, v150, v146
    v_dot2_f32_bf16 v145, v29, v29, v145
    v_dot2_f32_bf16 v144, v29, v150, v144
    v_dot2_f32_bf16 v146, v45, v150, v146
    v_dot2_f32_bf16 v145, v30, v30, v145
    v_dot2_f32_bf16 v144, v30, v150, v144
    v_dot2_f32_bf16 v146, v46, v150, v146
    v_dot2_f32_bf16 v145, v31, v31, v145
    v_dot2_f32_bf16 v144, v31, v150, v144
    v_dot2_f32_bf16 v146, v47, v150, v146
    v_dot2_f32_bf16 v145, v32, v32, v145
    v_dot2_f32_bf16 v144, v32, v150, v144
    v_dot2_f32_bf16 v146, v48, v150, v146
    v_dot2_f32_bf16 v145, v33, v33, v145
    v_dot2_f32_bf16 v144, v33, v150, v144
    v_dot2_f32_bf16 v146, v49, v150, v146
    v_dot2_f32_bf16 v145, v34, v34, v145
    v_dot2_f32_bf16 v144, v34, v150, v144
    v_dot2_f32_bf16 v146, v50, v150, v146
    v_dot2_f32_bf16 v145, v35, v35, v145
    v_dot2_f32_bf16 v144, v35, v150, v144
    v_dot2_f32_bf16 v146, v51, v150, v146
    v_dot2_f32_bf16 v145, v36, v36, v145
    v_dot2_f32_bf16 v144, v36, v150, v144
    v_dot2_f32_bf16 v146, v52, v150, v146
    v_dot2_f32_bf16 v145, v37, v37, v145
    v_dot2_f32_bf16 v144, v37, v150, v144
    v_dot2_f32_bf16 v146, v53, v150, v146
    v_dot2_f32_bf16 v145, v38, v38, v145
    v_dot2_f32_bf16 v144, v38, v150, v144
    v_dot2_f32_bf16 v146, v54, v150, v146
    v_dot2_f32_bf16 v145, v39, v39, v145
    v_dot2_f32_bf16 v144, v39, v150, v144
    v_dot2_f32_bf16 v146, v55, v150, v146
    s_cmp_lt_u32 s59, 8
    s_cbranch_scc1 M_CKV1
    s_nop 1
    v_mov_b32 v26, v144
    v_mov_b32 v27, v145
    s_nop 1
    v_permlane32_swap_b32 v144, v26
    v_permlane32_swap_b32 v145, v27
    s_nop 1
    v_add_f32 v144, v144, v26
    v_add_f32 v145, v145, v27
    v_mul_f32 v24, 0x3b000000, v144
    v_mul_f32 v26, v24, v24
    v_mul_f32 v27, 0x3b000000, v145
    v_sub_f32 v27, v27, v26
    v_max_f32 v27, 0, v27
    v_cvt_pk_bf16_f32 v24, v24, v24
    v_and_b32 v24, 0xffff0000, v24
    v_cvt_pk_bf16_f32 v27, v27, v27
    v_and_b32 v27, 0xffff0000, v27
    v_add_f32 v27, 0x3727c5ac, v27
    v_cvt_pk_bf16_f32 v27, v27, v27
    v_and_b32 v27, 0xffff0000, v27
    v_sqrt_f32 v25, v27
    s_nop 0
    v_cvt_pk_bf16_f32 v25, v25, v25
    v_and_b32 v25, 0xffff0000, v25
    v_mov_b32 v28, v146
    v_lshlrev_b32 v32, 3, v2
    s_lshl_b32 s13, s12, 9
    s_add_u32 s13, s13, 159744
    v_permlane32_swap_b32 v146, v28
    v_add_u32 v34, s13, v32
    ds_write_b64 v34, v[24:25]
    v_add_f32 v28, v146, v28
    v_sub_f32 v32, 0, v24
    v_cvt_pk_bf16_f32 v52, v32, v32
    v_cvt_pk_bf16_f32 v53, v32, v25
    v_cndmask_b32 v52, 0, v52, s[56:57]
    v_cndmask_b32 v53, 0, v53, s[56:57]
    v_mov_b32 v54, 0
    v_mov_b32 v55, 0
    v_rcp_f32 v34, v25
    v_cvt_pk_bf16_f32 v32, v28, v28
    v_and_b32 v32, 0xffff0000, v32
    v_sub_f32 v28, v28, v32
    v_cvt_pk_bf16_f32 v33, v28, v28
    v_and_b32 v33, 0xffff0000, v33
    v_sub_f32 v28, v28, v33
    v_cvt_pk_bf16_f32 v64, v32, v33
    v_cvt_pk_bf16_f32 v65, v28, v28
    v_and_b32 v65, 0xffff, v65
    v_mov_b32 v66, 0
    v_mov_b32 v67, 0
    s_nop 1
    v_mfma_f32_32x32x16_bf16 v[80:95], v[64:67], v[52:55], v[80:95]
    v_mfma_f32_32x32x16_bf16 v[96:111], v[52:55], v[64:67], v[96:111]
    v_lshlrev_b32 v26, 2, v3
    s_lshl_b32 s13, s12, 11
    s_add_u32 s13, s13, 147456
    v_add_u32 v26, s13, v26
    v_lshlrev_b32 v27, 4, v4
    v_add_u32 v27, s13, v27

    ds_write_b32 v26, v34
    s_lshl_b32 s59, s20, 2
    s_add_u32 s59, s59, s12
    s_mul_i32 s60, s59, 2064
    s_add_u32 s60, s60, 10485760
    s_waitcnt lgkmcnt(0)
    ds_read_b128 v[40:43], v27 offset:0
    ds_read_b128 v[44:47], v27 offset:32
    ds_read_b128 v[48:51], v27 offset:64
    ds_read_b128 v[52:55], v27 offset:96
    v_and_b32 v28, 19, v2
    v_bfe_u32 v29, v2, 2, 1
    v_lshl_or_b32 v28, v29, 3, v28
    v_bfe_u32 v29, v2, 3, 1
    v_lshl_or_b32 v28, v29, 2, v28
    v_lshlrev_b32 v28, 4, v28
    v_lshl_add_u32 v28, v4, 9, v28
    v_and_b32 v30, 15, v2
    v_lshlrev_b32 v30, 4, v30
    v_lshl_add_u32 v30, v4, 8, v30
    v_add_u32 v30, 0x400, v30
    v_xor_b32 v31, 1, v7
    v_lshl_add_u32 v30, v31, 28, v30

    v_pk_mul_f32 v[80:81], v[80:81], v[34:35] op_sel_hi:[1,0]
    v_pk_mul_f32 v[82:83], v[82:83], v[34:35] op_sel_hi:[1,0]
    v_pk_mul_f32 v[84:85], v[84:85], v[34:35] op_sel_hi:[1,0]
    v_pk_mul_f32 v[86:87], v[86:87], v[34:35] op_sel_hi:[1,0]
    v_cvt_pk_bf16_f32 v56, v80, v81
    v_cvt_pk_bf16_f32 v57, v82, v83
    v_cvt_pk_bf16_f32 v58, v84, v85
    v_cvt_pk_bf16_f32 v59, v86, v87
    buffer_store_dwordx4 v[56:59], v28, s[8:11], s60 offen sc1
    s_waitcnt lgkmcnt(0)
    v_pk_mul_f32 v[96:97], v[96:97], v[40:41]
    v_pk_mul_f32 v[98:99], v[98:99], v[42:43]
    v_pk_mul_f32 v[100:101], v[100:101], v[44:45]
    v_pk_mul_f32 v[102:103], v[102:103], v[46:47]
    v_pk_mul_f32 v[104:105], v[104:105], v[48:49]
    v_pk_mul_f32 v[106:107], v[106:107], v[50:51]
    v_pk_mul_f32 v[108:109], v[108:109], v[52:53]
    v_pk_mul_f32 v[110:111], v[110:111], v[54:55]
    v_cvt_pk_bf16_f32 v64, v96, v97
    v_cvt_pk_bf16_f32 v65, v98, v99
    v_cvt_pk_bf16_f32 v66, v100, v101
    v_cvt_pk_bf16_f32 v67, v102, v103
    v_cvt_pk_bf16_f32 v68, v104, v105
    v_cvt_pk_bf16_f32 v69, v106, v107
    v_cvt_pk_bf16_f32 v70, v108, v109
    v_cvt_pk_bf16_f32 v71, v110, v111
    buffer_store_dwordx4 v[64:67], v30, s[8:11], s60 offen sc1
    buffer_store_dwordx4 v[68:71], v30, s[8:11], s60 offen offset:512 sc1
    v_lshlrev_b32 v29, 28, v2
    v_mov_b32 v72, v150
    v_mov_b32 v73, v150
    v_mov_b32 v74, v150
    v_mov_b32 v75, v150
    buffer_store_dwordx4 v[72:75], v29, s[8:11], s60 offen offset:2048 sc1
    v_mov_b32 v60, 0
    v_dot2_f32_bf16 v60, v56, v56, v60
    v_dot2_f32_bf16 v60, v57, v57, v60
    v_dot2_f32_bf16 v60, v58, v58, v60
    v_dot2_f32_bf16 v60, v59, v59, v60
    s_nop 2
    v_mov_b32 v61, v60
    s_nop 1
    v_permlane32_swap_b32 v60, v61
    s_nop 1
    v_add_f32 v60, v60, v61
    v_mov_b32 v62, 163072
    v_mov_b32 v63, 1
    ds_max_u32 v62, v60 offset:88
    s_mov_b64 exec, 1
    s_waitcnt vmcnt(0) lgkmcnt(0)
    ds_add_rtn_u32 v61, v62, v63 offset:92
    s_waitcnt lgkmcnt(0)
    v_readfirstlane_b32 s13, v61
    s_cmp_eq_u32 s13, 3
    s_cbranch_scc0 M_CKV_NF
    s_mov_b32 exec_lo, -1
    ds_read_b32 v64, v62 offset:80
    ds_read_b32 v65, v62 offset:88
    s_lshl_b32 s13, s20, 3
    s_add_u32 s13, s13, 10821632
    v_mul_u32_u24 v61, 128, v2
    s_waitcnt lgkmcnt(0)
    buffer_store_dwordx2 v[64:65], v61, s[8:11], s13 offen sc1
M_CKV_NF:
    s_mov_b64 exec, -1
    s_mov_b32 s59, 0
    s_mov_b32 s60, 36864
M_CKV2:
    s_barrier
    ds_read_b128 v[24:27], v12
    ds_read_b64_tr_b16 v[40:41], v20
    ds_read_b64_tr_b16 v[42:43], v20 offset:512
    ds_read_b128 v[28:31], v13
    ds_read_b64_tr_b16 v[44:45], v21
    ds_read_b64_tr_b16 v[46:47], v21 offset:512
    ds_read_b128 v[32:35], v14
    ds_read_b64_tr_b16 v[48:49], v22
    ds_read_b64_tr_b16 v[50:51], v22 offset:512
    ds_read_b128 v[36:39], v15
    ds_read_b64_tr_b16 v[52:53], v23
    ds_read_b64_tr_b16 v[54:55], v23 offset:512
    s_waitcnt lgkmcnt(9)
    v_mfma_f32_32x32x16_bf16 v[128:143], v[40:43], v[24:27], v[128:143]
    s_waitcnt lgkmcnt(6)
    v_mfma_f32_32x32x16_bf16 v[128:143], v[44:47], v[28:31], v[128:143]
    s_waitcnt lgkmcnt(3)
    v_mfma_f32_32x32x16_bf16 v[128:143], v[48:51], v[32:35], v[128:143]
    s_waitcnt lgkmcnt(0)
    v_mfma_f32_32x32x16_bf16 v[128:143], v[52:55], v[36:39], v[128:143]
    s_add_u32 s59, s59, 1
    s_and_b32 s13, s59, 3
    s_cmp_eq_u32 s13, 0
    s_cselect_b32 s13, -110592, s60
    v_add_u32 v12, s13, v12
    v_add_u32 v13, s13, v13
    v_add_u32 v14, s13, v14
    v_add_u32 v15, s13, v15
    v_add_u32 v20, s13, v20
    v_add_u32 v21, s13, v21
    v_add_u32 v22, s13, v22
    v_add_u32 v23, s13, v23
    v_dot2_f32_bf16 v149, v40, v150, v149
    v_dot2_f32_bf16 v149, v41, v150, v149
    v_dot2_f32_bf16 v149, v42, v150, v149
    v_dot2_f32_bf16 v149, v43, v150, v149
    v_dot2_f32_bf16 v149, v44, v150, v149
    v_dot2_f32_bf16 v149, v45, v150, v149
    v_dot2_f32_bf16 v149, v46, v150, v149
    v_dot2_f32_bf16 v149, v47, v150, v149
    v_dot2_f32_bf16 v149, v48, v150, v149
    v_dot2_f32_bf16 v149, v49, v150, v149
    v_dot2_f32_bf16 v149, v50, v150, v149
    v_dot2_f32_bf16 v149, v51, v150, v149
    v_dot2_f32_bf16 v149, v52, v150, v149
    v_dot2_f32_bf16 v149, v53, v150, v149
    v_dot2_f32_bf16 v149, v54, v150, v149
    v_dot2_f32_bf16 v149, v55, v150, v149
    s_cmp_lt_u32 s59, 8
    s_cbranch_scc1 M_CKV2
    s_barrier
    v_lshlrev_b32 v32, 3, v2
    s_lshl_b32 s13, s23, 9
    s_add_u32 s13, s13, 159744
    v_add_u32 v35, s13, v32
    ds_read_b64 v[26:27], v35
    v_mov_b32 v31, v149
    s_nop 1
    v_permlane32_swap_b32 v149, v31
    s_nop 1
    v_add_f32 v31, v149, v31
    v_cvt_pk_bf16_f32 v32, v31, v31
    v_and_b32 v32, 0xffff0000, v32
    v_sub_f32 v31, v31, v32
    v_cvt_pk_bf16_f32 v33, v31, v31
    v_and_b32 v33, 0xffff0000, v33
    v_sub_f32 v31, v31, v33
    v_cvt_pk_bf16_f32 v60, v32, v33
    v_cvt_pk_bf16_f32 v61, v31, v31
    v_and_b32 v61, 0xffff, v61
    v_mov_b32 v62, 0
    v_mov_b32 v63, 0
    s_waitcnt lgkmcnt(0)
    v_sub_f32 v32, 0, v26
    v_cvt_pk_bf16_f32 v56, v32, v32
    v_cvt_pk_bf16_f32 v57, v32, v27
    v_cndmask_b32 v56, 0, v56, s[56:57]
    v_cndmask_b32 v57, 0, v57, s[56:57]
    v_mov_b32 v58, 0
    v_mov_b32 v59, 0
    v_rcp_f32 v36, v27
    s_nop 0
    v_mfma_f32_32x32x16_bf16 v[128:143], v[60:63], v[56:59], v[128:143]
    v_mul_f32 v36, 0x3eb8aa3b, v36
    s_lshl_b32 s13, s12, 11
    s_add_u32 s13, s13, 147456
    v_lshlrev_b32 v33, 4, v2
    v_add_u32 v38, s13, v33
    s_nop 7
    v_pk_mul_f32 v[128:129], v[128:129], v[36:37] op_sel_hi:[1,0]
    v_pk_mul_f32 v[130:131], v[130:131], v[36:37] op_sel_hi:[1,0]
    v_pk_mul_f32 v[132:133], v[132:133], v[36:37] op_sel_hi:[1,0]
    v_pk_mul_f32 v[134:135], v[134:135], v[36:37] op_sel_hi:[1,0]
    v_pk_mul_f32 v[136:137], v[136:137], v[36:37] op_sel_hi:[1,0]
    v_pk_mul_f32 v[138:139], v[138:139], v[36:37] op_sel_hi:[1,0]
    v_pk_mul_f32 v[140:141], v[140:141], v[36:37] op_sel_hi:[1,0]
    v_pk_mul_f32 v[142:143], v[142:143], v[36:37] op_sel_hi:[1,0]
    v_cvt_pk_bf16_f32 v40, v128, v129
    v_cvt_pk_bf16_f32 v41, v130, v131
    v_cvt_pk_bf16_f32 v42, v132, v133
    v_cvt_pk_bf16_f32 v43, v134, v135
    v_cvt_pk_bf16_f32 v44, v136, v137
    v_cvt_pk_bf16_f32 v45, v138, v139
    v_cvt_pk_bf16_f32 v46, v140, v141
    v_cvt_pk_bf16_f32 v47, v142, v143
    ds_write_b128 v38, v[40:43]
    ds_write_b128 v38, v[44:47] offset:1024
    s_mov_b32 s65, 2
M_ATT:
    v_lshlrev_b32 v3, 4, v2
    v_and_b32 v112, 31, v2
    v_lshrrev_b32 v113, 5, v2
    s_and_b32 s13, s3, 1
    s_mul_i32 s66, s13, 66048
    v_add_u32 v108, s66, v3
    v_lshlrev_b32 v109, 4, v112
    v_lshl_add_u32 v109, v113, 8, v109
    v_add_u32 v109, 0x400, v109
    v_add_u32 v110, 0x200, v109
    v_mov_b32 v115, 163840
    v_mov_b32 v116, 0x800
    v_cmp_eq_u32 vcc, 16, v112
    v_cmp_gt_u32 s[56:57], 16, v112
    v_mov_b32 v111, 0xdddddddd
    v_cndmask_b32 v115, v115, v116, vcc
    v_mov_b32 v117, 163072
    v_cndmask_b32 v109, v115, v109, s[56:57]
    v_cndmask_b32 v110, v115, v110, s[56:57]
    v_add_u32 v109, s66, v109
    v_add_u32 v110, s66, v110
    s_lshr_b32 s22, s3, 1
    s_lshl_b32 s23, s22, 11
    s_lshl_b32 s58, s13, 10
    s_add_u32 s23, s23, s58
    s_add_u32 s23, s23, 147456
    v_add_u32 v118, s23, v3
    v_xor_b32 v119, 0x400, v118
    s_lshl_b32 s23, s20, 1
    s_and_b32 s58, s21, 1
    s_add_u32 s23, s23, s58
    s_lshl_b32 s59, s23, 7
    s_lshr_b32 s60, s21, 1
    s_lshl_b32 s61, s60, 2
    s_add_u32 s59, s59, s61
    s_add_u32 s67, s59, 10827776
    s_lshl_b32 s23, s23, 1
    s_and_b32 s58, s22, 1
    s_add_u32 s23, s23, s58
    s_lshl_b32 s23, s23, 5
    s_add_u32 s23, s23, s61
    s_and_b32 s58, s22, 2
    s_add_u32 s23, s23, s58
    s_add_u32 s23, s23, s13
    s_lshl_b32 s23, s23, 10
    s_add_u32 s63, s23, 2162688

    v_mov_b32 v76, 0
    v_mov_b32 v92, 0
    v_mov_b32 v77, 0
    v_mov_b32 v93, 0
    v_mov_b32 v78, 0
    v_mov_b32 v94, 0
    v_mov_b32 v79, 0
    v_mov_b32 v95, 0
    v_mov_b32 v80, 0
    v_mov_b32 v96, 0
    v_mov_b32 v81, 0
    v_mov_b32 v97, 0
    v_mov_b32 v82, 0
    v_mov_b32 v98, 0
    v_mov_b32 v83, 0
    v_mov_b32 v99, 0
    v_mov_b32 v84, 0
    v_mov_b32 v100, 0
    v_mov_b32 v85, 0
    v_mov_b32 v101, 0
    v_mov_b32 v86, 0
    v_mov_b32 v102, 0
    v_mov_b32 v87, 0
    v_mov_b32 v103, 0
    v_mov_b32 v88, 0
    v_mov_b32 v104, 0
    v_mov_b32 v89, 0
    v_mov_b32 v105, 0
    v_mov_b32 v90, 0
    v_mov_b32 v106, 0
    v_mov_b32 v91, 0
    v_mov_b32 v107, 0
    v_mov_b32 v24, 0
    v_mov_b32 v25, 0
    v_mov_b32 v26, 0
    v_mov_b32 v27, 0
    v_mov_b32 v68, 0
    v_mov_b32 v69, 0
    v_mov_b32 v70, 0
    v_mov_b32 v71, 0
    v_mov_b32 v72, 0
    v_mov_b32 v73, 0
    v_mov_b32 v74, 0
    v_mov_b32 v75, 0
    v_mov_b32 v121, 0
    v_mov_b32 v122, 0
    v_mov_b32 v120, 1
    s_cmp_eq_u32 s65, 1
    s_cbranch_scc1 M_ATT_NB
    s_waitcnt lgkmcnt(0)
    s_barrier
M_ATT_NB:
    ds_read_b128 v[4:7], v118
    ds_read_b128 v[8:11], v119
    ds_read_b32 v123, v117 offset:84
    ds_read_b128 v[12:15], v108
    ds_read_b128 v[16:19], v109
    s_setprio 3
    s_mov_b32 s62, 0
    s_movk_i32 s58, 0xd6
    s_waitcnt lgkmcnt(2)
    s_mov_b64 exec, 1
    ds_add_u32 v117, v120 offset:72
    s_mov_b64 exec, -1
    v_dot2_f32_bf16 v121, v4, v4, v121
    v_dot2_f32_bf16 v122, v8, v8, v122
    v_dot2_f32_bf16 v121, v5, v5, v121
    v_dot2_f32_bf16 v122, v9, v9, v122
    v_dot2_f32_bf16 v121, v6, v6, v121
    v_dot2_f32_bf16 v122, v10, v10, v122
    v_dot2_f32_bf16 v121, v7, v7, v121
    v_dot2_f32_bf16 v122, v11, v11, v122
    s_nop 2
    v_mov_b32 v124, v121
    v_mov_b32 v125, v122
    s_nop 1
    v_permlane32_swap_b32 v121, v124
    v_permlane32_swap_b32 v122, v125
    s_nop 1
    v_add_f32 v121, v121, v124
    v_add_f32 v122, v122, v125
    v_max_f32 v121, v121, v122
    v_mul_f32 v121, v123, v121
    v_sqrt_f32 v121, v121
    s_nop 0
    v_mul_f32 v28, 0xbf8020c5, v121
    v_mov_b32 v29, v28
    v_mov_b32 v30, v28
    v_mov_b32 v31, v28
    v_mov_b32 v32, v28
    v_mov_b32 v33, v28
    v_mov_b32 v34, v28
    v_mov_b32 v35, v28
    v_mov_b32 v36, v28
    v_mov_b32 v37, v28
    v_mov_b32 v38, v28
    v_mov_b32 v39, v28
    v_mov_b32 v40, v28
    v_mov_b32 v41, v28
    v_mov_b32 v42, v28
    v_mov_b32 v43, v28
    s_waitcnt lgkmcnt(0)
    v_mfma_f32_32x32x16_bf16 v[44:59], v[12:15], v[4:7], v[28:43]
    s_nop 7
    s_branch M_BODY
.p2align 6
M_LOOP:
    s_bitcmp1_b32 s58, s62
    s_cbranch_scc1 M_SIDE
M_BODY:
    v_exp_f32 v44, v44
    v_exp_f32 v45, v45
    v_smfmac_f32_32x32x32_bf16 v[92:107], v[24:27], v[68:75], v111
    ds_read_b128 v[24:27], v110 offset:0
    v_exp_f32 v46, v46
    v_exp_f32 v47, v47
    v_exp_f32 v48, v48
    v_exp_f32 v49, v49
    v_mfma_f32_32x32x16_bf16 v[60:75], v[12:15], v[8:11], v[28:43]
    ds_read_b128 v[12:15], v108 offset:2064
    ds_read_b128 v[20:23], v109 offset:2064
    v_exp_f32 v50, v50
    v_exp_f32 v51, v51
    v_exp_f32 v52, v52
    v_exp_f32 v53, v53
    v_exp_f32 v54, v54
    v_exp_f32 v55, v55
    v_smfmac_f32_32x32x32_bf16 v[76:91], v[16:19], v[44:51], v111
    v_exp_f32 v56, v56
    v_exp_f32 v57, v57
    v_exp_f32 v58, v58
    v_exp_f32 v59, v59
    v_exp_f32 v60, v60
    s_waitcnt lgkmcnt(0)
    v_smfmac_f32_32x32x32_bf16 v[76:91], v[24:27], v[52:59], v111
    v_exp_f32 v61, v61
    v_exp_f32 v62, v62
    v_exp_f32 v63, v63
    v_exp_f32 v64, v64
    v_mfma_f32_32x32x16_bf16 v[44:59], v[12:15], v[4:7], v[28:43]
    v_exp_f32 v65, v65
    v_exp_f32 v66, v66
    v_exp_f32 v67, v67
    v_exp_f32 v68, v68
    v_exp_f32 v69, v69
    v_exp_f32 v70, v70
    v_smfmac_f32_32x32x32_bf16 v[92:107], v[16:19], v[60:67], v111
    v_exp_f32_e64 v71, v71
    v_exp_f32 v72, v72
    v_exp_f32 v73, v73
    v_exp_f32 v74, v74
    v_exp_f32 v75, v75
    v_exp_f32 v44, v44
    v_exp_f32 v45, v45
    v_smfmac_f32_32x32x32_bf16 v[92:107], v[24:27], v[68:75], v111
    ds_read_b128 v[24:27], v110 offset:2064
    v_exp_f32 v46, v46
    v_exp_f32 v47, v47
    v_exp_f32 v48, v48
    v_exp_f32 v49, v49
    v_mfma_f32_32x32x16_bf16 v[60:75], v[12:15], v[8:11], v[28:43]
    ds_read_b128 v[12:15], v108 offset:4128
    ds_read_b128 v[16:19], v109 offset:4128
    v_exp_f32 v50, v50
    v_exp_f32 v51, v51
    v_exp_f32 v52, v52
    v_exp_f32 v53, v53
    v_exp_f32 v54, v54
    v_exp_f32 v55, v55
    v_smfmac_f32_32x32x32_bf16 v[76:91], v[20:23], v[44:51], v111
    v_exp_f32 v56, v56
    v_exp_f32 v57, v57
    v_exp_f32 v58, v58
    v_exp_f32 v59, v59
    v_exp_f32 v60, v60
    s_waitcnt lgkmcnt(0)
    v_smfmac_f32_32x32x32_bf16 v[76:91], v[24:27], v[52:59], v111
    v_exp_f32 v61, v61
    v_exp_f32 v62, v62
    v_exp_f32 v63, v63
    v_exp_f32 v64, v64
    v_mfma_f32_32x32x16_bf16 v[44:59], v[12:15], v[4:7], v[28:43]
    v_exp_f32 v65, v65
    v_exp_f32 v66, v66
    v_exp_f32 v67, v67
    v_exp_f32 v68, v68
    v_exp_f32 v69, v69
    v_exp_f32 v70, v70
    v_smfmac_f32_32x32x32_bf16 v[92:107], v[20:23], v[60:67], v111
    v_exp_f32_e64 v71, v71
    v_exp_f32 v72, v72
    v_exp_f32 v73, v73
    v_exp_f32 v74, v74
    v_exp_f32 v75, v75
    v_exp_f32 v44, v44
    v_exp_f32 v45, v45
    v_smfmac_f32_32x32x32_bf16 v[92:107], v[24:27], v[68:75], v111
    ds_read_b128 v[24:27], v110 offset:4128
    v_exp_f32 v46, v46
    v_exp_f32 v47, v47
    v_exp_f32 v48, v48
    v_exp_f32 v49, v49
    v_mfma_f32_32x32x16_bf16 v[60:75], v[12:15], v[8:11], v[28:43]
    ds_read_b128 v[12:15], v108 offset:6192
    ds_read_b128 v[20:23], v109 offset:6192
    v_exp_f32 v50, v50
    v_exp_f32 v51, v51
    v_exp_f32 v52, v52
    v_exp_f32 v53, v53
    v_exp_f32 v54, v54
    v_exp_f32 v55, v55
    v_smfmac_f32_32x32x32_bf16 v[76:91], v[16:19], v[44:51], v111
    v_exp_f32 v56, v56
    v_exp_f32 v57, v57
    v_exp_f32 v58, v58
    v_exp_f32 v59, v59
    v_exp_f32 v60, v60
    s_waitcnt lgkmcnt(0)
    v_smfmac_f32_32x32x32_bf16 v[76:91], v[24:27], v[52:59], v111
    v_exp_f32 v61, v61
    v_exp_f32 v62, v62
    v_exp_f32 v63, v63
    v_exp_f32 v64, v64
    v_mfma_f32_32x32x16_bf16 v[44:59], v[12:15], v[4:7], v[28:43]
    v_exp_f32 v65, v65
    v_exp_f32 v66, v66
    v_exp_f32 v67, v67
    v_exp_f32 v68, v68
    v_exp_f32 v69, v69
    v_exp_f32 v70, v70
    v_smfmac_f32_32x32x32_bf16 v[92:107], v[16:19], v[60:67], v111
    v_exp_f32_e64 v71, v71
    v_exp_f32 v72, v72
    v_exp_f32 v73, v73
    v_exp_f32 v74, v74
    v_exp_f32 v75, v75
    v_exp_f32 v44, v44
    v_exp_f32 v45, v45
    v_smfmac_f32_32x32x32_bf16 v[92:107], v[24:27], v[68:75], v111
    ds_read_b128 v[24:27], v110 offset:6192
    v_exp_f32 v46, v46
    v_exp_f32 v47, v47
    v_exp_f32 v48, v48
    v_exp_f32 v49, v49
    v_mfma_f32_32x32x16_bf16 v[60:75], v[12:15], v[8:11], v[28:43]
    ds_read_b128 v[12:15], v108 offset:8256
    ds_read_b128 v[16:19], v109 offset:8256
    ds_read_b128 v[112:115], v117 offset:16
    v_exp_f32 v50, v50
    v_exp_f32 v51, v51
    v_exp_f32 v52, v52
    v_exp_f32 v53, v53
    v_exp_f32 v54, v54
    v_exp_f32 v55, v55
    v_smfmac_f32_32x32x32_bf16 v[76:91], v[20:23], v[44:51], v111
    v_exp_f32 v56, v56
    v_exp_f32 v57, v57
    v_exp_f32 v58, v58
    v_exp_f32 v59, v59
    v_exp_f32 v60, v60
    s_waitcnt lgkmcnt(0)
    v_smfmac_f32_32x32x32_bf16 v[76:91], v[24:27], v[52:59], v111
    v_exp_f32 v61, v61
    v_exp_f32 v62, v62
    v_exp_f32 v63, v63
    v_exp_f32 v64, v64
    v_mfma_f32_32x32x16_bf16 v[44:59], v[12:15], v[4:7], v[28:43]
    v_exp_f32 v65, v65
    v_exp_f32 v66, v66
    v_exp_f32 v67, v67
    v_exp_f32 v68, v68
    v_exp_f32 v69, v69
    v_exp_f32 v70, v70
    v_smfmac_f32_32x32x32_bf16 v[92:107], v[20:23], v[60:67], v111
    s_add_u32 s62, s62, 1
    s_cmp_lt_u32 s62, 8
    v_exp_f32_e64 v71, v71
    v_exp_f32 v72, v72
    v_exp_f32 v73, v73
    v_exp_f32 v74, v74
    v_exp_f32 v75, v75
    v_add_u32 v108, 8256, v108
    v_add_u32 v109, 8256, v109
    v_add_u32 v110, 8256, v110
    s_cbranch_scc1 M_LOOP
    v_smfmac_f32_32x32x32_bf16 v[92:107], v[24:27], v[68:75], v111
    s_mul_i32 s13, s3, 2304
    s_add_u32 s13, s13, 132352
    s_xor_b32 s22, s3, 1
    s_mul_i32 s22, s22, 2304
    s_add_u32 s22, s22, 132352
    v_add_u32 v112, s13, v3
    v_add_u32 v113, s22, v3
    v_lshlrev_b32 v114, 2, v2
    v_add_u32 v115, s22, v114
    v_add_u32 v114, s13, v114
    s_nop 2
    ds_write_b128 v112, v[92:95]
    ds_write_b128 v112, v[96:99] offset:1024
    ds_write_b32 v114, v100 offset:2048
    s_lshl_b32 s13, s3, 2
    v_add_u32 v116, s13, v117
    v_xor_b32 v119, 4, v116
    s_mov_b32 s22, 2097152
    s_waitcnt lgkmcnt(0)
    ds_write_b32 v116, v120 offset:112
M_PX:
    ds_read_b32 v118, v119 offset:112
    s_waitcnt lgkmcnt(0)
    v_readfirstlane_b32 s13, v118
    s_cmp_eq_u32 s13, 1
    s_cbranch_scc1 M_PXD
    s_sleep 1
    s_sub_u32 s22, s22, 1
    s_cbranch_scc0 M_PX
M_PXD:
    ds_read_b128 v[92:95], v113
    ds_read_b128 v[96:99], v113 offset:1024
    ds_read_b32 v100, v115 offset:2048
    ds_read_b32 v118, v117 offset:80
    s_waitcnt lgkmcnt(0)
    v_pk_add_f32 v[76:77], v[76:77], v[92:93]
    v_pk_add_f32 v[78:79], v[78:79], v[94:95]
    v_pk_add_f32 v[80:81], v[80:81], v[96:97]
    v_pk_add_f32 v[82:83], v[82:83], v[98:99]
    v_add_f32 v84, v84, v100
    v_min3_f32 v121, |v76|, |v77|, |v78|
    v_mov_b32 v124, v84
    v_min3_f32 v121, v121, |v79|, |v80|
    v_min3_f32 v121, v121, |v81|, |v82|
    v_permlane32_swap_b32 v84, v124
    v_min_f32 v121, v121, |v83|
    v_mov_b32 v122, 0x12800000
    v_mov_b32 v123, 0x21800000
    v_cmp_nge_f32 s[56:57], v121, v122
    v_cmp_nge_f32 vcc, v84, v123
    s_nop 1
    s_or_b64 s[56:57], s[56:57], vcc
    s_cmp_lg_u64 s[56:57], 0
    s_cbranch_scc1 M_FALLBACK
M_STORE:
    v_rcp_f32 v122, v84
    s_nop 0
    v_pk_mul_f32 v[76:77], v[76:77], v[122:123] op_sel_hi:[1,0]
    v_pk_mul_f32 v[78:79], v[78:79], v[122:123] op_sel_hi:[1,0]
    v_pk_mul_f32 v[80:81], v[80:81], v[122:123] op_sel_hi:[1,0]
    v_pk_mul_f32 v[82:83], v[82:83], v[122:123] op_sel_hi:[1,0]
    v_cvt_pk_bf16_f32 v124, v76, v77
    v_cvt_pk_bf16_f32 v125, v78, v79
    v_cvt_pk_bf16_f32 v126, v80, v81
    v_cvt_pk_bf16_f32 v127, v82, v83
    buffer_store_dwordx4 v[124:127], v3, s[8:11], s63 offen sc1
    v_mov_b32 v114, 0
    s_mov_b64 exec, 1
    ds_add_u32 v117, v120 offset:108
    s_waitcnt vmcnt(0)
    ds_add_rtn_u32 v113, v117, v120 offset:64
    s_waitcnt lgkmcnt(0)
    v_readfirstlane_b32 s13, v113
    s_cmp_eq_u32 s13, 7
    s_cbranch_scc0 M_NOFLAG
    buffer_store_dword v118, v114, s[8:11], s67 offen sc1
M_NOFLAG:
    s_mov_b64 exec, -1
M_END:
    s_endpgm
M_SIDE:
    s_cmp_eq_u32 s62, 1
    s_cbranch_scc1 M_POLL1
    s_cmp_eq_u32 s62, 4
    s_cbranch_scc1 M_POLL2
    s_cmp_eq_u32 s62, 7
    s_cbranch_scc1 M_POLL3
    s_setprio 2
    s_cmp_eq_u32 s62, 2
    s_cbranch_scc1 M_BODY
    s_setprio 0
    s_branch M_BODY
M_POLL1:
    v_readfirstlane_b32 s13, v112
    s_cmp_eq_u32 s13, 4
    s_cbranch_scc1 M_BODY
    s_mov_b32 s22, 2097152
M_POLL1L:
    s_sleep 2
    ds_read_b128 v[112:115], v117 offset:16
    s_waitcnt lgkmcnt(0)
    v_readfirstlane_b32 s13, v112
    s_cmp_eq_u32 s13, 4
    s_cbranch_scc1 M_BODY
    s_sub_u32 s22, s22, 1
    s_cbranch_scc0 M_POLL1L
    s_branch M_BODY
M_POLL2:
    s_setprio 1
    s_mov_b64 exec, 1
    ds_add_u32 v117, v120 offset:68
    s_mov_b64 exec, -1
    v_readfirstlane_b32 s13, v113
    s_cmp_eq_u32 s13, 4
    s_cbranch_scc1 M_BODY
    s_mov_b32 s22, 2097152
M_POLL2L:
    s_sleep 2
    ds_read_b128 v[112:115], v117 offset:16
    s_waitcnt lgkmcnt(0)
    v_readfirstlane_b32 s13, v113
    s_cmp_eq_u32 s13, 4
    s_cbranch_scc1 M_BODY
    s_sub_u32 s22, s22, 1
    s_cbranch_scc0 M_POLL2L
    s_branch M_BODY
M_POLL3:
    v_readfirstlane_b32 s13, v114
    s_cmp_eq_u32 s13, 4
    s_cbranch_scc1 M_BODY
    s_mov_b32 s22, 2097152
M_POLL3L:
    s_sleep 2
    ds_read_b128 v[112:115], v117 offset:16
    s_waitcnt lgkmcnt(0)
    v_readfirstlane_b32 s13, v114
    s_cmp_eq_u32 s13, 4
    s_cbranch_scc1 M_BODY
    s_sub_u32 s22, s22, 1
    s_cbranch_scc0 M_POLL3L
    s_branch M_BODY
M_FALLBACK:
    s_add_u32 s66, s66, 66048
    v_subrev_u32 v108, s66, v108
    v_subrev_u32 v109, s66, v109
    v_subrev_u32 v110, s66, v110
    s_mov_b32 s66, 10485760
    v_mov_b32 v121, 0xff800000
    v_mov_b32 v112, v108
    s_mov_b32 s62, 0
M_FB1:
    buffer_load_dwordx4 v[12:15], v112, s[8:11], s66 offen sc1
    v_add_u32 v112, 2064, v112
    s_waitcnt vmcnt(0)
    v_mfma_f32_32x32x16_bf16 v[44:59], v[12:15], v[4:7], 0
    s_nop 15
    v_max3_f32 v121, v121, v44, v45
    v_max3_f32 v121, v121, v46, v47
    v_max3_f32 v121, v121, v48, v49
    v_max3_f32 v121, v121, v50, v51
    v_max3_f32 v121, v121, v52, v53
    v_max3_f32 v121, v121, v54, v55
    v_max3_f32 v121, v121, v56, v57
    v_max3_f32 v121, v121, v58, v59
    s_add_u32 s62, s62, 1
    s_cmp_lt_u32 s62, 64
    s_cbranch_scc1 M_FB1
    v_mov_b32 v122, v121
    s_nop 1
    v_permlane32_swap_b32 v121, v122
    s_nop 1
    v_max_f32 v121, v121, v122
    v_sub_f32 v28, 0, v121
    v_mov_b32 v29, v28
    v_mov_b32 v30, v28
    v_mov_b32 v31, v28
    v_mov_b32 v32, v28
    v_mov_b32 v33, v28
    v_mov_b32 v34, v28
    v_mov_b32 v35, v28
    v_mov_b32 v36, v28
    v_mov_b32 v37, v28
    v_mov_b32 v38, v28
    v_mov_b32 v39, v28
    v_mov_b32 v40, v28
    v_mov_b32 v41, v28
    v_mov_b32 v42, v28
    v_mov_b32 v43, v28
    v_mov_b32 v76, 0
    v_mov_b32 v77, 0
    v_mov_b32 v78, 0
    v_mov_b32 v79, 0
    v_mov_b32 v80, 0
    v_mov_b32 v81, 0
    v_mov_b32 v82, 0
    v_mov_b32 v83, 0
    v_mov_b32 v84, 0
    v_mov_b32 v85, 0
    v_mov_b32 v86, 0
    v_mov_b32 v87, 0
    v_mov_b32 v88, 0
    v_mov_b32 v89, 0
    v_mov_b32 v90, 0
    v_mov_b32 v91, 0
    s_mov_b32 s62, 0
M_FB2:
    buffer_load_dwordx4 v[12:15], v108, s[8:11], s66 offen sc1
    buffer_load_dwordx4 v[16:19], v109, s[8:11], s66 offen sc1
    buffer_load_dwordx4 v[24:27], v110, s[8:11], s66 offen sc1
    v_add_u32 v108, 2064, v108
    v_add_u32 v109, 2064, v109
    v_add_u32 v110, 2064, v110
    s_waitcnt vmcnt(0)
    v_mfma_f32_32x32x16_bf16 v[44:59], v[12:15], v[4:7], v[28:43]
    s_nop 15
    v_exp_f32 v44, v44
    v_exp_f32 v45, v45
    v_exp_f32 v46, v46
    v_exp_f32 v47, v47
    v_exp_f32 v48, v48
    v_exp_f32 v49, v49
    v_exp_f32 v50, v50
    v_exp_f32 v51, v51
    v_exp_f32 v52, v52
    v_exp_f32 v53, v53
    v_exp_f32 v54, v54
    v_exp_f32 v55, v55
    v_exp_f32 v56, v56
    v_exp_f32 v57, v57
    v_exp_f32 v58, v58
    v_exp_f32 v59, v59
    s_nop 1
    v_smfmac_f32_32x32x32_bf16 v[76:91], v[16:19], v[44:51], v111
    v_smfmac_f32_32x32x32_bf16 v[76:91], v[24:27], v[52:59], v111
    s_add_u32 s62, s62, 1
    s_cmp_lt_u32 s62, 64
    s_cbranch_scc1 M_FB2
    s_nop 15
    v_mov_b32 v124, v84
    s_nop 1
    v_permlane32_swap_b32 v84, v124
    s_nop 1
    s_branch M_STORE
M_G:
    s_setprio 3
    v_lshlrev_b32 v3, 4, v2
    v_mov_b32 v14, 163072
    v_mov_b32 v13, 1
    v_mov_b32 v15, 0
    v_lshl_add_u32 v5, v2, 2, v14
    s_lshr_b32 s19, s14, 1
    s_lshl_b32 s19, s19, 3
    s_and_b32 s16, s15, 7
    s_add_u32 s19, s19, s16
    s_and_b32 s16, s14, 1
    s_lshl_b32 s16, s16, 2
    s_lshr_b32 s17, s15, 3
    s_add_u32 s16, s16, s17
    s_and_b32 s22, s12, 1
    s_lshr_b32 s23, s12, 1
    s_cmp_lg_u32 s12, 0
    s_cbranch_scc1 M_G_NZ
    ds_write_b32 v5, v15

M_G_NZ:
    s_waitcnt lgkmcnt(0)
    s_add_u32 s8, s4, 0x3fffff
    s_addc_u32 s9, s5, 0
    s_and_b32 s8, s8, 0xffc00000
    s_mov_b32 s10, 16777216
    s_mov_b32 s11, 0x00020000
    s_mov_b32 s24, s54
    s_mov_b32 s25, s55
    s_mov_b32 s26, 256
    s_mov_b32 s27, 0x00020000
    s_or_b32 s13, s12, s2
    s_cmp_lg_u32 s13, 0
    s_cbranch_scc1 M_G_N0
    s_mov_b32 s13, 10813440
    s_mov_b64 exec, 1
    buffer_load_dword v12, v15, s[8:11], s13 offen sc1
    s_waitcnt vmcnt(0)
    s_mov_b32 s17, 0x9e3779b1
    v_mul_lo_u32 v12, v12, s17
    v_add_u32 v12, 0x7f4a7c15, v12
    buffer_store_dwordx2 v[12:13], v15, s[24:27], 0 offen sc1
    buffer_store_dword v12, v15, s[8:11], s13 offen sc1
    s_mov_b64 exec, -1
M_G_N0:
    s_mov_b32 s28, s48
    s_mov_b32 s29, s49
    s_mov_b32 s30, 1409024
    s_mov_b32 s31, 0x00020000
    s_mov_b32 s56, s40
    s_mov_b32 s57, s41
    s_mov_b32 s58, 524288
    s_mov_b32 s59, 0x00020000
    s_mov_b32 s60, s32
    s_mov_b32 s61, s33
    s_mov_b32 s62, 2097152
    s_mov_b32 s63, 0x00020000
    s_mov_b32 s36, s52
    s_mov_b32 s37, s53
    s_mov_b32 s38, 2097152
    s_mov_b32 s39, 0x00020000
    s_mov_b32 s40, s50
    s_mov_b32 s41, s51
    s_mov_b32 s42, 1024
    s_mov_b32 s43, 0x00020000
    v_lshrrev_b32 v5, 3, v2
    v_lshlrev_b32 v5, 10, v5
    v_bfe_u32 v6, v2, 4, 1
    v_lshlrev_b32 v6, 2, v6
    v_and_b32 v7, 7, v2
    v_xor_b32 v6, v6, v7
    v_lshl_add_u32 v4, v6, 4, v5
    v_lshrrev_b32 v8, 5, v2
    v_bfe_u32 v9, v2, 2, 2
    v_lshl_add_u32 v6, v8, 2, v9
    v_lshlrev_b32 v6, 7, v6
    v_bfe_u32 v9, v2, 4, 1
    v_bfe_u32 v10, v2, 1, 1
    v_lshl_add_u32 v9, v9, 1, v10
    v_bfe_u32 v10, v2, 3, 1
    v_lshl_add_u32 v9, v10, 2, v9
    v_lshl_add_u32 v6, v9, 4, v6
    v_and_b32 v10, 1, v2
    v_lshl_add_u32 v6, v10, 3, v6
    s_lshl_b32 s13, s23, 6
    v_xor_b32 v6, s13, v6
    v_xor_b32 v7, 64, v6
    s_mul_i32 s44, s12, 6144
    s_add_u32 s44, s44, 132352
    s_mul_i32 s45, s23, 66304
    v_add_u32 v10, s45, v6
    v_add_u32 v11, s45, v7
    v_add_u32 v6, s44, v6
    v_add_u32 v7, s44, v7
    s_lshl_b32 s13, s12, 2
    s_add_u32 s13, s13, 163072
    v_mov_b32 v12, s13
    s_lshl_b32 s46, s19, 1
    s_add_u32 s46, s46, s22
    s_mul_i32 s47, s46, 86
    s_mul_i32 s48, s23, 43
    s_add_u32 s47, s47, s48
    s_lshl_b32 s47, s47, 10
    s_add_u32 s47, s47, 4325376
    s_lshl_b32 s48, s48, 14
    s_lshl_b32 s49, s16, 7
    s_add_u32 s48, s48, s49

    v_mov_b32 v16, 0
    v_mov_b32 v17, 0
    v_mov_b32 v18, 0
    v_mov_b32 v19, 0
    v_mov_b32 v20, 0
    v_mov_b32 v21, 0
    v_mov_b32 v22, 0
    v_mov_b32 v23, 0
    v_mov_b32 v24, 0
    v_mov_b32 v25, 0
    v_mov_b32 v26, 0
    v_mov_b32 v27, 0
    v_mov_b32 v28, 0
    v_mov_b32 v29, 0
    v_mov_b32 v30, 0
    v_mov_b32 v31, 0
    v_mov_b32 v32, 0
    v_mov_b32 v33, 0
    v_mov_b32 v34, 0
    v_mov_b32 v35, 0
    v_mov_b32 v36, 0
    v_mov_b32 v37, 0
    v_mov_b32 v38, 0
    v_mov_b32 v39, 0
    v_mov_b32 v40, 0
    v_mov_b32 v41, 0
    v_mov_b32 v42, 0
    v_mov_b32 v43, 0
    v_mov_b32 v44, 0
    v_mov_b32 v45, 0
    v_mov_b32 v46, 0
    v_mov_b32 v47, 0
    s_barrier
    s_barrier
    s_barrier
    s_mov_b64 exec, 1
    s_lshl_b32 s13, s12, 8
    buffer_load_dwordx2 v[104:105], v15, s[24:27], s13 offen sc1
    s_mov_b64 exec, -1
    s_barrier
    s_barrier
    s_barrier
    s_barrier
    s_cmp_lg_u32 s12, 0
    s_cbranch_scc1 M_G_NPX
    s_mov_b32 s13, 131072
    s_mov_b64 exec, 1
    s_branch M_G_NP1
M_G_NP:
    buffer_load_dwordx2 v[104:105], v15, s[24:27], 0 offen sc1
M_G_NP1:
    s_waitcnt vmcnt(0)
    v_readfirstlane_b32 s17, v105
    v_readfirstlane_b32 s18, v104
    s_cmp_eq_u32 s17, 1
    s_cbranch_scc1 M_G_NPD
    s_sleep 8
    s_sub_u32 s13, s13, 1
    s_cbranch_scc0 M_G_NP
M_G_NPD:
    ds_write_b32 v14, v104 offset:80
    s_mov_b64 exec, -1
    s_waitcnt lgkmcnt(0)
M_G_NPX:
    s_barrier
    s_cmp_lg_u32 s21, 15
    s_cbranch_scc1 M_G_NKV
    s_barrier
    s_barrier
    s_barrier
    s_barrier
    s_barrier
    s_barrier
    s_barrier
    s_barrier
M_G_NKV:
    v_lshlrev_b32 v106, 3, v2
    v_lshlrev_b32 v107, 2, v2
    s_and_b32 s50, s2, 31
    s_mul_i32 s50, s50, 128
    s_add_u32 s50, s50, 10821632
    s_barrier
    s_cmp_lg_u32 s12, 0
    s_cbranch_scc1 M_G_KPO
    s_mov_b32 s13, 131072
    s_mov_b64 exec, 65535
    buffer_load_dwordx2 v[102:103], v106, s[8:11], s50 offen sc1
    s_sleep 8
M_G_KP:
    buffer_load_dwordx2 v[104:105], v106, s[8:11], s50 offen sc1
    s_waitcnt vmcnt(1)
    v_cmp_eq_u32 vcc, s18, v102
    v_mov_b32 v101, v103
    s_nop 0
    s_cmp_eq_u32 vcc_lo, 65535
    s_cbranch_scc1 M_G_KPD
    buffer_load_dwordx2 v[102:103], v106, s[8:11], s50 offen sc1
    s_waitcnt vmcnt(1)
    v_cmp_eq_u32 vcc, s18, v104
    v_mov_b32 v101, v105
    s_nop 0
    s_cmp_eq_u32 vcc_lo, 65535
    s_cbranch_scc1 M_G_KPD
    s_sub_u32 s13, s13, 1
    s_cbranch_scc0 M_G_KP
M_G_KPD:
    ds_write_b32 v14, v13 offset:96
    ds_max_u32 v14, v101 offset:84
    s_mov_b64 exec, -1
    s_branch M_G_KPX
M_G_KPO:
    s_mov_b32 s13, 2097152
M_G_KPL:
    ds_read_b32 v5, v14 offset:96
    s_waitcnt lgkmcnt(0)
    v_readfirstlane_b32 s17, v5
    s_cmp_eq_u32 s17, 1
    s_cbranch_scc1 M_G_KPLD
    s_sleep 1
    s_sub_u32 s13, s13, 1
    s_cbranch_scc0 M_G_KPL
M_G_KPLD:
M_G_KPX:
    s_lshl_b32 s50, s12, 10
    s_mov_b32 m0, s50
    s_add_u32 s51, s50, 10485760
    buffer_load_dwordx4 v3, s[8:11], s51 offen lds
    s_add_u32 m0, s50, 65536
    s_add_u32 s51, s51, 65536
    buffer_load_dwordx4 v3, s[8:11], s51 offen lds
    s_add_u32 s50, s50, 4096
    s_mov_b32 m0, s50
    s_add_u32 s51, s50, 10485760
    buffer_load_dwordx4 v3, s[8:11], s51 offen lds
    s_add_u32 m0, s50, 65536
    s_add_u32 s51, s51, 65536
    buffer_load_dwordx4 v3, s[8:11], s51 offen lds
    s_add_u32 s50, s50, 4096
    s_mov_b32 m0, s50
    s_add_u32 s51, s50, 10485760
    buffer_load_dwordx4 v3, s[8:11], s51 offen lds
    s_add_u32 m0, s50, 65536
    s_add_u32 s51, s51, 65536
    buffer_load_dwordx4 v3, s[8:11], s51 offen lds
    s_add_u32 s50, s50, 4096
    s_mov_b32 m0, s50
    s_add_u32 s51, s50, 10485760
    buffer_load_dwordx4 v3, s[8:11], s51 offen lds
    s_add_u32 m0, s50, 65536
    s_add_u32 s51, s51, 65536
    buffer_load_dwordx4 v3, s[8:11], s51 offen lds
    s_add_u32 s50, s50, 4096
    s_waitcnt vmcnt(2) lgkmcnt(0)
    s_barrier
    s_mov_b32 m0, s50
    s_add_u32 s51, s50, 10485760
    buffer_load_dwordx4 v3, s[8:11], s51 offen lds
    s_add_u32 m0, s50, 65536
    s_add_u32 s51, s51, 65536
    buffer_load_dwordx4 v3, s[8:11], s51 offen lds
    s_add_u32 s50, s50, 4096
    s_mov_b32 m0, s50
    s_add_u32 s51, s50, 10485760
    buffer_load_dwordx4 v3, s[8:11], s51 offen lds
    s_add_u32 m0, s50, 65536
    s_add_u32 s51, s51, 65536
    buffer_load_dwordx4 v3, s[8:11], s51 offen lds
    s_add_u32 s50, s50, 4096
    s_mov_b32 m0, s50
    s_add_u32 s51, s50, 10485760
    buffer_load_dwordx4 v3, s[8:11], s51 offen lds
    s_add_u32 m0, s50, 65536
    s_add_u32 s51, s51, 65536
    buffer_load_dwordx4 v3, s[8:11], s51 offen lds
    s_add_u32 s50, s50, 4096
    s_mov_b32 m0, s50
    s_add_u32 s51, s50, 10485760
    buffer_load_dwordx4 v3, s[8:11], s51 offen lds
    s_add_u32 m0, s50, 65536
    s_add_u32 s51, s51, 65536
    buffer_load_dwordx4 v3, s[8:11], s51 offen lds
    s_add_u32 s50, s50, 4096
    s_mov_b32 m0, s50
    s_add_u32 s51, s50, 10485760
    buffer_load_dwordx4 v3, s[8:11], s51 offen lds
    s_add_u32 m0, s50, 65536
    s_add_u32 s51, s51, 65536
    buffer_load_dwordx4 v3, s[8:11], s51 offen lds
    s_add_u32 s50, s50, 4096
    s_mov_b32 m0, s50
    s_add_u32 s51, s50, 10485760
    buffer_load_dwordx4 v3, s[8:11], s51 offen lds
    s_add_u32 m0, s50, 65536
    s_add_u32 s51, s51, 65536
    buffer_load_dwordx4 v3, s[8:11], s51 offen lds
    s_add_u32 s50, s50, 4096
    s_waitcnt vmcnt(2)
    s_mov_b64 exec, 1
    ds_add_u32 v14, v13 offset:16
    s_mov_b64 exec, -1
    s_mov_b32 m0, s50
    s_add_u32 s51, s50, 10485760
    buffer_load_dwordx4 v3, s[8:11], s51 offen lds
    s_add_u32 m0, s50, 65536
    s_add_u32 s51, s51, 65536
    buffer_load_dwordx4 v3, s[8:11], s51 offen lds
    s_add_u32 s50, s50, 4096
    s_mov_b32 m0, s50
    s_add_u32 s51, s50, 10485760
    buffer_load_dwordx4 v3, s[8:11], s51 offen lds
    s_add_u32 m0, s50, 65536
    s_add_u32 s51, s51, 65536
    buffer_load_dwordx4 v3, s[8:11], s51 offen lds
    s_add_u32 s50, s50, 4096
    s_mov_b32 m0, s50
    s_add_u32 s51, s50, 10485760
    buffer_load_dwordx4 v3, s[8:11], s51 offen lds
    s_add_u32 m0, s50, 65536
    s_add_u32 s51, s51, 65536
    buffer_load_dwordx4 v3, s[8:11], s51 offen lds
    s_add_u32 s50, s50, 4096
    s_mov_b32 m0, s50
    s_add_u32 s51, s50, 10485760
    buffer_load_dwordx4 v3, s[8:11], s51 offen lds
    s_add_u32 m0, s50, 65536
    s_add_u32 s51, s51, 65536
    buffer_load_dwordx4 v3, s[8:11], s51 offen lds
    s_add_u32 s50, s50, 4096
    s_mov_b32 m0, s50
    s_add_u32 s51, s50, 10485760
    buffer_load_dwordx4 v3, s[8:11], s51 offen lds
    s_add_u32 m0, s50, 65536
    s_add_u32 s51, s51, 65536
    buffer_load_dwordx4 v3, s[8:11], s51 offen lds
    s_add_u32 s50, s50, 4096
    s_mov_b32 m0, s50
    s_add_u32 s51, s50, 10485760
    buffer_load_dwordx4 v3, s[8:11], s51 offen lds
    s_add_u32 m0, s50, 65536
    s_add_u32 s51, s51, 65536
    buffer_load_dwordx4 v3, s[8:11], s51 offen lds
    s_add_u32 s50, s50, 4096
    s_mov_b32 s50, 65536
    s_mov_b32 m0, s50
    s_add_u32 s51, s50, 10485760
    buffer_load_dwordx4 v3, s[8:11], s51 offen lds
    s_add_u32 m0, s50, 65536
    s_add_u32 s51, s51, 65536
    buffer_load_dwordx4 v3, s[8:11], s51 offen lds
    s_add_u32 s50, s50, 4096
    s_waitcnt vmcnt(0)
    s_mov_b64 exec, 1
    ds_add_u32 v14, v13 offset:20
    s_mov_b64 exec, -1
    s_mov_b32 s13, 2097152
M_G_QR:
    ds_read_b32 v5, v14 offset:72
    s_waitcnt lgkmcnt(0)
    v_readfirstlane_b32 s17, v5
    s_cmp_eq_u32 s17, 8
    s_cbranch_scc1 M_G_QRD
    s_sleep 4
    s_sub_u32 s13, s13, 1
    s_cbranch_scc0 M_G_QR
M_G_QRD:
    s_and_b32 s64, s19, 7
    s_mul_i32 s64, s64, 5
    s_and_b32 s13, s16, 3
    s_add_u32 s64, s64, s13
    s_lshl_b32 s55, s64, 14
    s_lshl_b32 s64, s64, 10
    s_add_u32 m0, s44, 0
    s_add_u32 s51, s48, s55
    buffer_load_dwordx4 v4, s[28:31], s51 offen lds
    s_add_u32 s51, s51, 7168
    buffer_load_dwordx4 v4, s[28:31], s51 offen offset:1024 lds
    s_add_u32 s55, s55, 16384
    s_cmp_eq_u32 s55, 704512
    s_cselect_b32 s55, 0, s55
    s_add_u32 m0, s44, 2048
    s_add_u32 s51, s48, s55
    buffer_load_dwordx4 v4, s[28:31], s51 offen lds
    s_add_u32 s51, s51, 7168
    buffer_load_dwordx4 v4, s[28:31], s51 offen offset:1024 lds
    s_add_u32 s55, s55, 16384
    s_cmp_eq_u32 s55, 704512
    s_cselect_b32 s55, 0, s55
    s_add_u32 m0, s44, 4096
    s_add_u32 s51, s48, s55
    buffer_load_dwordx4 v4, s[28:31], s51 offen lds
    s_add_u32 s51, s51, 7168
    buffer_load_dwordx4 v4, s[28:31], s51 offen offset:1024 lds
    s_add_u32 s55, s55, 16384
    s_cmp_eq_u32 s55, 704512
    s_cselect_b32 s55, 0, s55
    v_and_b32 v9, 31, v2
    v_lshlrev_b32 v9, 10, v9
    v_lshl_add_u32 v9, v8, 4, v9
    v_lshlrev_b32 v15, 4, v8
    s_lshl_b32 s52, s46, 15
    s_lshl_b32 s53, s23, 6
    s_add_u32 s53, s53, s49
    s_add_u32 s52, s52, s53

    buffer_load_dwordx4 v[128:131], v9, s[60:63], s52 offen
    buffer_load_dwordx4 v[132:135], v9, s[60:63], s52 offen offset:32
    buffer_load_dwordx4 v[136:139], v15, s[40:43], s53 offen
    buffer_load_dwordx4 v[140:143], v15, s[40:43], s53 offen offset:32
    s_lshr_b32 s50, s19, 1
    s_mul_i32 s50, s50, 128
    s_add_u32 s50, s50, 10825728
    s_cmp_lg_u32 s12, 0
    s_cbranch_scc1 M_G_HPO
    s_mov_b32 s13, 131072
    s_mov_b64 exec, 32767
    buffer_load_dword v102, v107, s[8:11], s50 offen sc1
    s_sleep 8
M_G_HP:
    buffer_load_dword v104, v107, s[8:11], s50 offen sc1
    s_waitcnt vmcnt(1)
    v_cmp_eq_u32 vcc, s18, v102
    v_mov_b32 v101, v103
    s_nop 0
    s_cmp_eq_u32 vcc_lo, 32767
    s_cbranch_scc1 M_G_HPD
    buffer_load_dword v102, v107, s[8:11], s50 offen sc1
    s_waitcnt vmcnt(1)
    v_cmp_eq_u32 vcc, s18, v104
    v_mov_b32 v101, v105
    s_nop 0
    s_cmp_eq_u32 vcc_lo, 32767
    s_cbranch_scc1 M_G_HPD
    s_sub_u32 s13, s13, 1
    s_cbranch_scc0 M_G_HP
M_G_HPD:
    ds_write_b32 v14, v13 offset:100
    s_mov_b64 exec, -1
    s_branch M_G_HPX
M_G_HPO:
    s_mov_b32 s13, 2097152
M_G_HPL:
    ds_read_b32 v5, v14 offset:100
    s_waitcnt lgkmcnt(0)
    v_readfirstlane_b32 s17, v5
    s_cmp_eq_u32 s17, 1
    s_cbranch_scc1 M_G_HPLD
    s_sleep 1
    s_sub_u32 s13, s13, 1
    s_cbranch_scc0 M_G_HPL
M_G_HPLD:
M_G_HPX:
    s_add_u32 s51, s47, s64
    buffer_load_dwordx4 v[48:51], v3, s[8:11], s51 offen
    s_add_u32 s64, s64, 1024
    s_cmp_eq_u32 s64, 44032
    s_cselect_b32 s64, 0, s64
    s_add_u32 s51, s47, s64
    buffer_load_dwordx4 v[52:55], v3, s[8:11], s51 offen
    s_add_u32 s64, s64, 1024
    s_cmp_eq_u32 s64, 44032
    s_cselect_b32 s64, 0, s64
    s_add_u32 s51, s47, s64
    buffer_load_dwordx4 v[56:59], v3, s[8:11], s51 offen
    s_add_u32 s64, s64, 1024
    s_cmp_eq_u32 s64, 44032
    s_cselect_b32 s64, 0, s64
    s_add_u32 s51, s47, s64
    buffer_load_dwordx4 v[60:63], v3, s[8:11], s51 offen
    s_add_u32 s64, s64, 1024
    s_cmp_eq_u32 s64, 44032
    s_cselect_b32 s64, 0, s64
    s_add_u32 s51, s47, s64
    buffer_load_dwordx4 v[64:67], v3, s[8:11], s51 offen
    s_add_u32 s64, s64, 1024
    s_cmp_eq_u32 s64, 44032
    s_cselect_b32 s64, 0, s64
    s_add_u32 s51, s47, s64
    buffer_load_dwordx4 v[68:71], v3, s[8:11], s51 offen
    s_add_u32 s64, s64, 1024
    s_cmp_eq_u32 s64, 44032
    s_cselect_b32 s64, 0, s64
    s_add_u32 s51, s47, s64
    buffer_load_dwordx4 v[72:75], v3, s[8:11], s51 offen
    s_add_u32 s64, s64, 1024
    s_cmp_eq_u32 s64, 44032
    s_cselect_b32 s64, 0, s64
    s_add_u32 s51, s47, s64
    buffer_load_dwordx4 v[76:79], v3, s[8:11], s51 offen
    s_add_u32 s64, s64, 1024
    s_cmp_eq_u32 s64, 44032
    s_cselect_b32 s64, 0, s64
    s_add_u32 s51, s47, s64
    buffer_load_dwordx4 v[80:83], v3, s[8:11], s51 offen
    s_add_u32 s64, s64, 1024
    s_cmp_eq_u32 s64, 44032
    s_cselect_b32 s64, 0, s64
    s_add_u32 s51, s47, s64
    buffer_load_dwordx4 v[84:87], v3, s[8:11], s51 offen
    s_add_u32 s64, s64, 1024
    s_cmp_eq_u32 s64, 44032
    s_cselect_b32 s64, 0, s64
    s_add_u32 s51, s47, s64
    buffer_load_dwordx4 v[88:91], v3, s[8:11], s51 offen
    s_add_u32 s64, s64, 1024
    s_cmp_eq_u32 s64, 44032
    s_cselect_b32 s64, 0, s64
    s_add_u32 s51, s47, s64
    buffer_load_dwordx4 v[92:95], v3, s[8:11], s51 offen
    s_add_u32 s64, s64, 1024
    s_cmp_eq_u32 s64, 44032
    s_cselect_b32 s64, 0, s64
    s_waitcnt vmcnt(11)
    ds_read_b64_tr_b16 v[112:113], v6 offset:0
    ds_read_b64_tr_b16 v[114:115], v6 offset:1024
    ds_read_b64_tr_b16 v[116:117], v7 offset:0
    ds_read_b64_tr_b16 v[118:119], v7 offset:1024
    s_waitcnt lgkmcnt(0)
    s_add_u32 m0, s44, 0
    s_add_u32 s51, s48, s55
    buffer_load_dwordx4 v4, s[28:31], s51 offen lds
    s_add_u32 s51, s51, 7168
    buffer_load_dwordx4 v4, s[28:31], s51 offen offset:1024 lds
    s_add_u32 s55, s55, 16384
    s_cmp_eq_u32 s55, 704512
    s_cselect_b32 s55, 0, s55
    s_add_u32 s51, s47, s64
    buffer_load_dwordx4 v[96:99], v3, s[8:11], s51 offen
    s_add_u32 s64, s64, 1024
    s_cmp_eq_u32 s64, 44032
    s_cselect_b32 s64, 0, s64
    v_mfma_f32_32x32x16_bf16 v[16:31], v[112:115], v[48:51], v[16:31]
    v_mfma_f32_32x32x16_bf16 v[32:47], v[116:119], v[48:51], v[32:47]
    s_waitcnt vmcnt(13)
    ds_read_b64_tr_b16 v[112:113], v6 offset:2048
    ds_read_b64_tr_b16 v[114:115], v6 offset:3072
    ds_read_b64_tr_b16 v[116:117], v7 offset:2048
    ds_read_b64_tr_b16 v[118:119], v7 offset:3072
    s_waitcnt lgkmcnt(0)
    s_add_u32 m0, s44, 2048
    s_add_u32 s51, s48, s55
    buffer_load_dwordx4 v4, s[28:31], s51 offen lds
    s_add_u32 s51, s51, 7168
    buffer_load_dwordx4 v4, s[28:31], s51 offen offset:1024 lds
    s_add_u32 s55, s55, 16384
    s_cmp_eq_u32 s55, 704512
    s_cselect_b32 s55, 0, s55
    s_add_u32 s51, s47, s64
    buffer_load_dwordx4 v[100:103], v3, s[8:11], s51 offen
    s_add_u32 s64, s64, 1024
    s_cmp_eq_u32 s64, 44032
    s_cselect_b32 s64, 0, s64
    v_mfma_f32_32x32x16_bf16 v[16:31], v[112:115], v[52:55], v[16:31]
    v_mfma_f32_32x32x16_bf16 v[32:47], v[116:119], v[52:55], v[32:47]
    s_waitcnt vmcnt(15)
    ds_read_b64_tr_b16 v[112:113], v6 offset:4096
    ds_read_b64_tr_b16 v[114:115], v6 offset:5120
    ds_read_b64_tr_b16 v[116:117], v7 offset:4096
    ds_read_b64_tr_b16 v[118:119], v7 offset:5120
    v_lshlrev_b32 v144, 16, v128
    v_and_b32 v145, 0xffff0000, v128
    v_lshlrev_b32 v128, 16, v136
    v_and_b32 v136, 0xffff0000, v136
    v_add_f32 v144, v144, v128
    v_add_f32 v145, v145, v136
    v_lshlrev_b32 v146, 16, v129
    v_and_b32 v147, 0xffff0000, v129
    v_lshlrev_b32 v129, 16, v137
    v_and_b32 v137, 0xffff0000, v137
    v_add_f32 v146, v146, v129
    v_add_f32 v147, v147, v137
    v_lshlrev_b32 v148, 16, v130
    v_and_b32 v149, 0xffff0000, v130
    v_lshlrev_b32 v130, 16, v138
    v_and_b32 v138, 0xffff0000, v138
    v_add_f32 v148, v148, v130
    v_add_f32 v149, v149, v138
    v_lshlrev_b32 v150, 16, v131
    v_and_b32 v151, 0xffff0000, v131
    v_lshlrev_b32 v131, 16, v139
    v_and_b32 v139, 0xffff0000, v139
    v_add_f32 v150, v150, v131
    v_add_f32 v151, v151, v139
    v_lshlrev_b32 v152, 16, v132
    v_and_b32 v153, 0xffff0000, v132
    v_lshlrev_b32 v132, 16, v140
    v_and_b32 v140, 0xffff0000, v140
    v_add_f32 v152, v152, v132
    v_add_f32 v153, v153, v140
    v_lshlrev_b32 v154, 16, v133
    v_and_b32 v155, 0xffff0000, v133
    v_lshlrev_b32 v133, 16, v141
    v_and_b32 v141, 0xffff0000, v141
    v_add_f32 v154, v154, v133
    v_add_f32 v155, v155, v141
    v_lshlrev_b32 v156, 16, v134
    v_and_b32 v157, 0xffff0000, v134
    v_lshlrev_b32 v134, 16, v142
    v_and_b32 v142, 0xffff0000, v142
    v_add_f32 v156, v156, v134
    v_add_f32 v157, v157, v142
    v_lshlrev_b32 v158, 16, v135
    v_and_b32 v159, 0xffff0000, v135
    v_lshlrev_b32 v135, 16, v143
    v_and_b32 v143, 0xffff0000, v143
    v_add_f32 v158, v158, v135
    v_add_f32 v159, v159, v143
    s_waitcnt lgkmcnt(0)
    s_add_u32 m0, s44, 4096
    s_add_u32 s51, s48, s55
    buffer_load_dwordx4 v4, s[28:31], s51 offen lds
    s_add_u32 s51, s51, 7168
    buffer_load_dwordx4 v4, s[28:31], s51 offen offset:1024 lds
    s_add_u32 s55, s55, 16384
    s_cmp_eq_u32 s55, 704512
    s_cselect_b32 s55, 0, s55
    s_add_u32 s51, s47, s64
    buffer_load_dwordx4 v[104:107], v3, s[8:11], s51 offen
    s_add_u32 s64, s64, 1024
    s_cmp_eq_u32 s64, 44032
    s_cselect_b32 s64, 0, s64
    v_mfma_f32_32x32x16_bf16 v[16:31], v[112:115], v[56:59], v[16:31]
    v_mfma_f32_32x32x16_bf16 v[32:47], v[116:119], v[56:59], v[32:47]
    s_waitcnt vmcnt(7)
    ds_read_b64_tr_b16 v[112:113], v6 offset:0
    ds_read_b64_tr_b16 v[114:115], v6 offset:1024
    ds_read_b64_tr_b16 v[116:117], v7 offset:0
    ds_read_b64_tr_b16 v[118:119], v7 offset:1024
    s_waitcnt lgkmcnt(0)
    s_add_u32 m0, s44, 0
    s_add_u32 s51, s48, s55
    buffer_load_dwordx4 v4, s[28:31], s51 offen lds
    s_add_u32 s51, s51, 7168
    buffer_load_dwordx4 v4, s[28:31], s51 offen offset:1024 lds
    s_add_u32 s55, s55, 16384
    s_cmp_eq_u32 s55, 704512
    s_cselect_b32 s55, 0, s55
    s_add_u32 s51, s47, s64
    buffer_load_dwordx4 v[108:111], v3, s[8:11], s51 offen
    s_add_u32 s64, s64, 1024
    s_cmp_eq_u32 s64, 44032
    s_cselect_b32 s64, 0, s64
    v_mfma_f32_32x32x16_bf16 v[16:31], v[112:115], v[60:63], v[16:31]
    v_mfma_f32_32x32x16_bf16 v[32:47], v[116:119], v[60:63], v[32:47]
    s_waitcnt vmcnt(7)
    ds_read_b64_tr_b16 v[112:113], v6 offset:2048
    ds_read_b64_tr_b16 v[114:115], v6 offset:3072
    ds_read_b64_tr_b16 v[116:117], v7 offset:2048
    ds_read_b64_tr_b16 v[118:119], v7 offset:3072
    s_waitcnt lgkmcnt(0)
    s_add_u32 m0, s44, 2048
    s_add_u32 s51, s48, s55
    buffer_load_dwordx4 v4, s[28:31], s51 offen lds
    s_add_u32 s51, s51, 7168
    buffer_load_dwordx4 v4, s[28:31], s51 offen offset:1024 lds
    s_add_u32 s55, s55, 16384
    s_cmp_eq_u32 s55, 704512
    s_cselect_b32 s55, 0, s55
    s_add_u32 s51, s47, s64
    buffer_load_dwordx4 v[48:51], v3, s[8:11], s51 offen
    s_add_u32 s64, s64, 1024
    s_cmp_eq_u32 s64, 44032
    s_cselect_b32 s64, 0, s64
    v_mfma_f32_32x32x16_bf16 v[16:31], v[112:115], v[64:67], v[16:31]
    v_mfma_f32_32x32x16_bf16 v[32:47], v[116:119], v[64:67], v[32:47]
    s_waitcnt vmcnt(7)
    ds_read_b64_tr_b16 v[112:113], v6 offset:4096
    ds_read_b64_tr_b16 v[114:115], v6 offset:5120
    ds_read_b64_tr_b16 v[116:117], v7 offset:4096
    ds_read_b64_tr_b16 v[118:119], v7 offset:5120
    s_waitcnt lgkmcnt(0)
    s_add_u32 m0, s44, 4096
    s_add_u32 s51, s48, s55
    buffer_load_dwordx4 v4, s[28:31], s51 offen lds
    s_add_u32 s51, s51, 7168
    buffer_load_dwordx4 v4, s[28:31], s51 offen offset:1024 lds
    s_add_u32 s55, s55, 16384
    s_cmp_eq_u32 s55, 704512
    s_cselect_b32 s55, 0, s55
    s_add_u32 s51, s47, s64
    buffer_load_dwordx4 v[52:55], v3, s[8:11], s51 offen
    s_add_u32 s64, s64, 1024
    s_cmp_eq_u32 s64, 44032
    s_cselect_b32 s64, 0, s64
    v_mfma_f32_32x32x16_bf16 v[16:31], v[112:115], v[68:71], v[16:31]
    v_mfma_f32_32x32x16_bf16 v[32:47], v[116:119], v[68:71], v[32:47]
    s_waitcnt vmcnt(7)
    ds_read_b64_tr_b16 v[112:113], v6 offset:0
    ds_read_b64_tr_b16 v[114:115], v6 offset:1024
    ds_read_b64_tr_b16 v[116:117], v7 offset:0
    ds_read_b64_tr_b16 v[118:119], v7 offset:1024
    s_waitcnt lgkmcnt(0)
    s_add_u32 m0, s44, 0
    s_add_u32 s51, s48, s55
    buffer_load_dwordx4 v4, s[28:31], s51 offen lds
    s_add_u32 s51, s51, 7168
    buffer_load_dwordx4 v4, s[28:31], s51 offen offset:1024 lds
    s_add_u32 s55, s55, 16384
    s_cmp_eq_u32 s55, 704512
    s_cselect_b32 s55, 0, s55
    s_add_u32 s51, s47, s64
    buffer_load_dwordx4 v[56:59], v3, s[8:11], s51 offen
    s_add_u32 s64, s64, 1024
    s_cmp_eq_u32 s64, 44032
    s_cselect_b32 s64, 0, s64
    v_mfma_f32_32x32x16_bf16 v[16:31], v[112:115], v[72:75], v[16:31]
    v_mfma_f32_32x32x16_bf16 v[32:47], v[116:119], v[72:75], v[32:47]
    s_waitcnt vmcnt(7)
    ds_read_b64_tr_b16 v[112:113], v6 offset:2048
    ds_read_b64_tr_b16 v[114:115], v6 offset:3072
    ds_read_b64_tr_b16 v[116:117], v7 offset:2048
    ds_read_b64_tr_b16 v[118:119], v7 offset:3072
    s_waitcnt lgkmcnt(0)
    s_add_u32 m0, s44, 2048
    s_add_u32 s51, s48, s55
    buffer_load_dwordx4 v4, s[28:31], s51 offen lds
    s_add_u32 s51, s51, 7168
    buffer_load_dwordx4 v4, s[28:31], s51 offen offset:1024 lds
    s_add_u32 s55, s55, 16384
    s_cmp_eq_u32 s55, 704512
    s_cselect_b32 s55, 0, s55
    s_add_u32 s51, s47, s64
    buffer_load_dwordx4 v[60:63], v3, s[8:11], s51 offen
    s_add_u32 s64, s64, 1024
    s_cmp_eq_u32 s64, 44032
    s_cselect_b32 s64, 0, s64
    v_mfma_f32_32x32x16_bf16 v[16:31], v[112:115], v[76:79], v[16:31]
    v_mfma_f32_32x32x16_bf16 v[32:47], v[116:119], v[76:79], v[32:47]
    s_waitcnt vmcnt(7)
    ds_read_b64_tr_b16 v[112:113], v6 offset:4096
    ds_read_b64_tr_b16 v[114:115], v6 offset:5120
    ds_read_b64_tr_b16 v[116:117], v7 offset:4096
    ds_read_b64_tr_b16 v[118:119], v7 offset:5120
    s_waitcnt lgkmcnt(0)
    s_add_u32 m0, s44, 4096
    s_add_u32 s51, s48, s55
    buffer_load_dwordx4 v4, s[28:31], s51 offen lds
    s_add_u32 s51, s51, 7168
    buffer_load_dwordx4 v4, s[28:31], s51 offen offset:1024 lds
    s_add_u32 s55, s55, 16384
    s_cmp_eq_u32 s55, 704512
    s_cselect_b32 s55, 0, s55
    s_add_u32 s51, s47, s64
    buffer_load_dwordx4 v[64:67], v3, s[8:11], s51 offen
    s_add_u32 s64, s64, 1024
    s_cmp_eq_u32 s64, 44032
    s_cselect_b32 s64, 0, s64
    v_mfma_f32_32x32x16_bf16 v[16:31], v[112:115], v[80:83], v[16:31]
    v_mfma_f32_32x32x16_bf16 v[32:47], v[116:119], v[80:83], v[32:47]
    s_waitcnt vmcnt(7)
    ds_read_b64_tr_b16 v[112:113], v6 offset:0
    ds_read_b64_tr_b16 v[114:115], v6 offset:1024
    ds_read_b64_tr_b16 v[116:117], v7 offset:0
    ds_read_b64_tr_b16 v[118:119], v7 offset:1024
    s_waitcnt lgkmcnt(0)
    s_add_u32 m0, s44, 0
    s_add_u32 s51, s48, s55
    buffer_load_dwordx4 v4, s[28:31], s51 offen lds
    s_add_u32 s51, s51, 7168
    buffer_load_dwordx4 v4, s[28:31], s51 offen offset:1024 lds
    s_add_u32 s55, s55, 16384
    s_cmp_eq_u32 s55, 704512
    s_cselect_b32 s55, 0, s55
    s_add_u32 s51, s47, s64
    buffer_load_dwordx4 v[68:71], v3, s[8:11], s51 offen
    s_add_u32 s64, s64, 1024
    s_cmp_eq_u32 s64, 44032
    s_cselect_b32 s64, 0, s64
    v_mfma_f32_32x32x16_bf16 v[16:31], v[112:115], v[84:87], v[16:31]
    v_mfma_f32_32x32x16_bf16 v[32:47], v[116:119], v[84:87], v[32:47]
    s_waitcnt vmcnt(7)
    ds_read_b64_tr_b16 v[112:113], v6 offset:2048
    ds_read_b64_tr_b16 v[114:115], v6 offset:3072
    ds_read_b64_tr_b16 v[116:117], v7 offset:2048
    ds_read_b64_tr_b16 v[118:119], v7 offset:3072
    s_waitcnt lgkmcnt(0)
    s_add_u32 m0, s44, 2048
    s_add_u32 s51, s48, s55
    buffer_load_dwordx4 v4, s[28:31], s51 offen lds
    s_add_u32 s51, s51, 7168
    buffer_load_dwordx4 v4, s[28:31], s51 offen offset:1024 lds
    s_add_u32 s55, s55, 16384
    s_cmp_eq_u32 s55, 704512
    s_cselect_b32 s55, 0, s55
    s_add_u32 s51, s47, s64
    buffer_load_dwordx4 v[72:75], v3, s[8:11], s51 offen
    s_add_u32 s64, s64, 1024
    s_cmp_eq_u32 s64, 44032
    s_cselect_b32 s64, 0, s64
    v_mfma_f32_32x32x16_bf16 v[16:31], v[112:115], v[88:91], v[16:31]
    v_mfma_f32_32x32x16_bf16 v[32:47], v[116:119], v[88:91], v[32:47]
    s_waitcnt vmcnt(7)
    ds_read_b64_tr_b16 v[112:113], v6 offset:4096
    ds_read_b64_tr_b16 v[114:115], v6 offset:5120
    ds_read_b64_tr_b16 v[116:117], v7 offset:4096
    ds_read_b64_tr_b16 v[118:119], v7 offset:5120
    s_waitcnt lgkmcnt(0)
    s_add_u32 m0, s44, 4096
    s_add_u32 s51, s48, s55
    buffer_load_dwordx4 v4, s[28:31], s51 offen lds
    s_add_u32 s51, s51, 7168
    buffer_load_dwordx4 v4, s[28:31], s51 offen offset:1024 lds
    s_add_u32 s55, s55, 16384
    s_cmp_eq_u32 s55, 704512
    s_cselect_b32 s55, 0, s55
    s_add_u32 s51, s47, s64
    buffer_load_dwordx4 v[76:79], v3, s[8:11], s51 offen
    s_add_u32 s64, s64, 1024
    s_cmp_eq_u32 s64, 44032
    s_cselect_b32 s64, 0, s64
    v_mfma_f32_32x32x16_bf16 v[16:31], v[112:115], v[92:95], v[16:31]
    v_mfma_f32_32x32x16_bf16 v[32:47], v[116:119], v[92:95], v[32:47]
    s_waitcnt vmcnt(7)
    ds_read_b64_tr_b16 v[112:113], v6 offset:0
    ds_read_b64_tr_b16 v[114:115], v6 offset:1024
    ds_read_b64_tr_b16 v[116:117], v7 offset:0
    ds_read_b64_tr_b16 v[118:119], v7 offset:1024
    s_waitcnt lgkmcnt(0)
    s_add_u32 m0, s44, 0
    s_add_u32 s51, s48, s55
    buffer_load_dwordx4 v4, s[28:31], s51 offen lds
    s_add_u32 s51, s51, 7168
    buffer_load_dwordx4 v4, s[28:31], s51 offen offset:1024 lds
    s_add_u32 s55, s55, 16384
    s_cmp_eq_u32 s55, 704512
    s_cselect_b32 s55, 0, s55
    s_add_u32 s51, s47, s64
    buffer_load_dwordx4 v[80:83], v3, s[8:11], s51 offen
    s_add_u32 s64, s64, 1024
    s_cmp_eq_u32 s64, 44032
    s_cselect_b32 s64, 0, s64
    v_mfma_f32_32x32x16_bf16 v[16:31], v[112:115], v[96:99], v[16:31]
    v_mfma_f32_32x32x16_bf16 v[32:47], v[116:119], v[96:99], v[32:47]
    s_waitcnt vmcnt(7)
    ds_read_b64_tr_b16 v[112:113], v6 offset:2048
    ds_read_b64_tr_b16 v[114:115], v6 offset:3072
    ds_read_b64_tr_b16 v[116:117], v7 offset:2048
    ds_read_b64_tr_b16 v[118:119], v7 offset:3072
    s_waitcnt lgkmcnt(0)
    s_add_u32 m0, s44, 2048
    s_add_u32 s51, s48, s55
    buffer_load_dwordx4 v4, s[28:31], s51 offen lds
    s_add_u32 s51, s51, 7168
    buffer_load_dwordx4 v4, s[28:31], s51 offen offset:1024 lds
    s_add_u32 s55, s55, 16384
    s_cmp_eq_u32 s55, 704512
    s_cselect_b32 s55, 0, s55
    s_add_u32 s51, s47, s64
    buffer_load_dwordx4 v[84:87], v3, s[8:11], s51 offen
    s_add_u32 s64, s64, 1024
    s_cmp_eq_u32 s64, 44032
    s_cselect_b32 s64, 0, s64
    v_mfma_f32_32x32x16_bf16 v[16:31], v[112:115], v[100:103], v[16:31]
    v_mfma_f32_32x32x16_bf16 v[32:47], v[116:119], v[100:103], v[32:47]
    s_waitcnt vmcnt(7)
    ds_read_b64_tr_b16 v[112:113], v6 offset:4096
    ds_read_b64_tr_b16 v[114:115], v6 offset:5120
    ds_read_b64_tr_b16 v[116:117], v7 offset:4096
    ds_read_b64_tr_b16 v[118:119], v7 offset:5120
    s_waitcnt lgkmcnt(0)
    s_add_u32 m0, s44, 4096
    s_add_u32 s51, s48, s55
    buffer_load_dwordx4 v4, s[28:31], s51 offen lds
    s_add_u32 s51, s51, 7168
    buffer_load_dwordx4 v4, s[28:31], s51 offen offset:1024 lds
    s_add_u32 s55, s55, 16384
    s_cmp_eq_u32 s55, 704512
    s_cselect_b32 s55, 0, s55
    s_add_u32 s51, s47, s64
    buffer_load_dwordx4 v[88:91], v3, s[8:11], s51 offen
    s_add_u32 s64, s64, 1024
    s_cmp_eq_u32 s64, 44032
    s_cselect_b32 s64, 0, s64
    v_mfma_f32_32x32x16_bf16 v[16:31], v[112:115], v[104:107], v[16:31]
    v_mfma_f32_32x32x16_bf16 v[32:47], v[116:119], v[104:107], v[32:47]
    s_waitcnt vmcnt(7)
    ds_read_b64_tr_b16 v[112:113], v6 offset:0
    ds_read_b64_tr_b16 v[114:115], v6 offset:1024
    ds_read_b64_tr_b16 v[116:117], v7 offset:0
    ds_read_b64_tr_b16 v[118:119], v7 offset:1024
    s_waitcnt lgkmcnt(0)
    s_add_u32 m0, s44, 0
    s_add_u32 s51, s48, s55
    buffer_load_dwordx4 v4, s[28:31], s51 offen lds
    s_add_u32 s51, s51, 7168
    buffer_load_dwordx4 v4, s[28:31], s51 offen offset:1024 lds
    s_add_u32 s55, s55, 16384
    s_cmp_eq_u32 s55, 704512
    s_cselect_b32 s55, 0, s55
    s_add_u32 s51, s47, s64
    buffer_load_dwordx4 v[92:95], v3, s[8:11], s51 offen
    s_add_u32 s64, s64, 1024
    s_cmp_eq_u32 s64, 44032
    s_cselect_b32 s64, 0, s64
    v_mfma_f32_32x32x16_bf16 v[16:31], v[112:115], v[108:111], v[16:31]
    v_mfma_f32_32x32x16_bf16 v[32:47], v[116:119], v[108:111], v[32:47]
    s_waitcnt vmcnt(7)
    ds_read_b64_tr_b16 v[112:113], v6 offset:2048
    ds_read_b64_tr_b16 v[114:115], v6 offset:3072
    ds_read_b64_tr_b16 v[116:117], v7 offset:2048
    ds_read_b64_tr_b16 v[118:119], v7 offset:3072
    s_waitcnt lgkmcnt(0)
    s_add_u32 m0, s44, 2048
    s_add_u32 s51, s48, s55
    buffer_load_dwordx4 v4, s[28:31], s51 offen lds
    s_add_u32 s51, s51, 7168
    buffer_load_dwordx4 v4, s[28:31], s51 offen offset:1024 lds
    s_add_u32 s55, s55, 16384
    s_cmp_eq_u32 s55, 704512
    s_cselect_b32 s55, 0, s55
    s_add_u32 s51, s47, s64
    buffer_load_dwordx4 v[96:99], v3, s[8:11], s51 offen
    s_add_u32 s64, s64, 1024
    s_cmp_eq_u32 s64, 44032
    s_cselect_b32 s64, 0, s64
    v_mfma_f32_32x32x16_bf16 v[16:31], v[112:115], v[48:51], v[16:31]
    v_mfma_f32_32x32x16_bf16 v[32:47], v[116:119], v[48:51], v[32:47]
    s_waitcnt vmcnt(7)
    ds_read_b64_tr_b16 v[112:113], v6 offset:4096
    ds_read_b64_tr_b16 v[114:115], v6 offset:5120
    ds_read_b64_tr_b16 v[116:117], v7 offset:4096
    ds_read_b64_tr_b16 v[118:119], v7 offset:5120
    s_waitcnt lgkmcnt(0)
    s_add_u32 m0, s44, 4096
    s_add_u32 s51, s48, s55
    buffer_load_dwordx4 v4, s[28:31], s51 offen lds
    s_add_u32 s51, s51, 7168
    buffer_load_dwordx4 v4, s[28:31], s51 offen offset:1024 lds
    s_add_u32 s55, s55, 16384
    s_cmp_eq_u32 s55, 704512
    s_cselect_b32 s55, 0, s55
    s_add_u32 s51, s47, s64
    buffer_load_dwordx4 v[100:103], v3, s[8:11], s51 offen
    s_add_u32 s64, s64, 1024
    s_cmp_eq_u32 s64, 44032
    s_cselect_b32 s64, 0, s64
    v_mfma_f32_32x32x16_bf16 v[16:31], v[112:115], v[52:55], v[16:31]
    v_mfma_f32_32x32x16_bf16 v[32:47], v[116:119], v[52:55], v[32:47]
    s_waitcnt vmcnt(7)
    ds_read_b64_tr_b16 v[112:113], v6 offset:0
    ds_read_b64_tr_b16 v[114:115], v6 offset:1024
    ds_read_b64_tr_b16 v[116:117], v7 offset:0
    ds_read_b64_tr_b16 v[118:119], v7 offset:1024
    s_waitcnt lgkmcnt(0)
    s_add_u32 m0, s44, 0
    s_add_u32 s51, s48, s55
    buffer_load_dwordx4 v4, s[28:31], s51 offen lds
    s_add_u32 s51, s51, 7168
    buffer_load_dwordx4 v4, s[28:31], s51 offen offset:1024 lds
    s_add_u32 s55, s55, 16384
    s_cmp_eq_u32 s55, 704512
    s_cselect_b32 s55, 0, s55
    s_add_u32 s51, s47, s64
    buffer_load_dwordx4 v[104:107], v3, s[8:11], s51 offen
    s_add_u32 s64, s64, 1024
    s_cmp_eq_u32 s64, 44032
    s_cselect_b32 s64, 0, s64
    v_mfma_f32_32x32x16_bf16 v[16:31], v[112:115], v[56:59], v[16:31]
    v_mfma_f32_32x32x16_bf16 v[32:47], v[116:119], v[56:59], v[32:47]
    s_waitcnt vmcnt(7)
    ds_read_b64_tr_b16 v[112:113], v6 offset:2048
    ds_read_b64_tr_b16 v[114:115], v6 offset:3072
    ds_read_b64_tr_b16 v[116:117], v7 offset:2048
    ds_read_b64_tr_b16 v[118:119], v7 offset:3072
    s_waitcnt lgkmcnt(0)
    s_add_u32 m0, s44, 2048
    s_add_u32 s51, s48, s55
    buffer_load_dwordx4 v4, s[28:31], s51 offen lds
    s_add_u32 s51, s51, 7168
    buffer_load_dwordx4 v4, s[28:31], s51 offen offset:1024 lds
    s_add_u32 s55, s55, 16384
    s_cmp_eq_u32 s55, 704512
    s_cselect_b32 s55, 0, s55
    s_add_u32 s51, s47, s64
    buffer_load_dwordx4 v[108:111], v3, s[8:11], s51 offen
    s_add_u32 s64, s64, 1024
    s_cmp_eq_u32 s64, 44032
    s_cselect_b32 s64, 0, s64
    v_mfma_f32_32x32x16_bf16 v[16:31], v[112:115], v[60:63], v[16:31]
    v_mfma_f32_32x32x16_bf16 v[32:47], v[116:119], v[60:63], v[32:47]
    s_waitcnt vmcnt(7)
    ds_read_b64_tr_b16 v[112:113], v6 offset:4096
    ds_read_b64_tr_b16 v[114:115], v6 offset:5120
    ds_read_b64_tr_b16 v[116:117], v7 offset:4096
    ds_read_b64_tr_b16 v[118:119], v7 offset:5120
    s_waitcnt lgkmcnt(0)
    s_add_u32 m0, s44, 4096
    s_add_u32 s51, s48, s55
    buffer_load_dwordx4 v4, s[28:31], s51 offen lds
    s_add_u32 s51, s51, 7168
    buffer_load_dwordx4 v4, s[28:31], s51 offen offset:1024 lds
    s_add_u32 s55, s55, 16384
    s_cmp_eq_u32 s55, 704512
    s_cselect_b32 s55, 0, s55
    s_add_u32 s51, s47, s64
    buffer_load_dwordx4 v[48:51], v3, s[8:11], s51 offen
    s_add_u32 s64, s64, 1024
    s_cmp_eq_u32 s64, 44032
    s_cselect_b32 s64, 0, s64
    v_mfma_f32_32x32x16_bf16 v[16:31], v[112:115], v[64:67], v[16:31]
    v_mfma_f32_32x32x16_bf16 v[32:47], v[116:119], v[64:67], v[32:47]
    s_waitcnt vmcnt(7)
    ds_read_b64_tr_b16 v[112:113], v6 offset:0
    ds_read_b64_tr_b16 v[114:115], v6 offset:1024
    ds_read_b64_tr_b16 v[116:117], v7 offset:0
    ds_read_b64_tr_b16 v[118:119], v7 offset:1024
    s_waitcnt lgkmcnt(0)
    s_add_u32 m0, s44, 0
    s_add_u32 s51, s48, s55
    buffer_load_dwordx4 v4, s[28:31], s51 offen lds
    s_add_u32 s51, s51, 7168
    buffer_load_dwordx4 v4, s[28:31], s51 offen offset:1024 lds
    s_add_u32 s55, s55, 16384
    s_cmp_eq_u32 s55, 704512
    s_cselect_b32 s55, 0, s55
    s_add_u32 s51, s47, s64
    buffer_load_dwordx4 v[52:55], v3, s[8:11], s51 offen
    s_add_u32 s64, s64, 1024
    s_cmp_eq_u32 s64, 44032
    s_cselect_b32 s64, 0, s64
    v_mfma_f32_32x32x16_bf16 v[16:31], v[112:115], v[68:71], v[16:31]
    v_mfma_f32_32x32x16_bf16 v[32:47], v[116:119], v[68:71], v[32:47]
    s_waitcnt vmcnt(7)
    ds_read_b64_tr_b16 v[112:113], v6 offset:2048
    ds_read_b64_tr_b16 v[114:115], v6 offset:3072
    ds_read_b64_tr_b16 v[116:117], v7 offset:2048
    ds_read_b64_tr_b16 v[118:119], v7 offset:3072
    s_waitcnt lgkmcnt(0)
    s_add_u32 m0, s44, 2048
    s_add_u32 s51, s48, s55
    buffer_load_dwordx4 v4, s[28:31], s51 offen lds
    s_add_u32 s51, s51, 7168
    buffer_load_dwordx4 v4, s[28:31], s51 offen offset:1024 lds
    s_add_u32 s55, s55, 16384
    s_cmp_eq_u32 s55, 704512
    s_cselect_b32 s55, 0, s55
    s_add_u32 s51, s47, s64
    buffer_load_dwordx4 v[56:59], v3, s[8:11], s51 offen
    s_add_u32 s64, s64, 1024
    s_cmp_eq_u32 s64, 44032
    s_cselect_b32 s64, 0, s64
    v_mfma_f32_32x32x16_bf16 v[16:31], v[112:115], v[72:75], v[16:31]
    v_mfma_f32_32x32x16_bf16 v[32:47], v[116:119], v[72:75], v[32:47]
    s_waitcnt vmcnt(7)
    ds_read_b64_tr_b16 v[112:113], v6 offset:4096
    ds_read_b64_tr_b16 v[114:115], v6 offset:5120
    ds_read_b64_tr_b16 v[116:117], v7 offset:4096
    ds_read_b64_tr_b16 v[118:119], v7 offset:5120
    s_waitcnt lgkmcnt(0)
    s_add_u32 m0, s44, 4096
    s_add_u32 s51, s48, s55
    buffer_load_dwordx4 v4, s[28:31], s51 offen lds
    s_add_u32 s51, s51, 7168
    buffer_load_dwordx4 v4, s[28:31], s51 offen offset:1024 lds
    s_add_u32 s55, s55, 16384
    s_cmp_eq_u32 s55, 704512
    s_cselect_b32 s55, 0, s55
    s_add_u32 s51, s47, s64
    buffer_load_dwordx4 v[60:63], v3, s[8:11], s51 offen
    s_add_u32 s64, s64, 1024
    s_cmp_eq_u32 s64, 44032
    s_cselect_b32 s64, 0, s64
    v_mfma_f32_32x32x16_bf16 v[16:31], v[112:115], v[76:79], v[16:31]
    v_mfma_f32_32x32x16_bf16 v[32:47], v[116:119], v[76:79], v[32:47]
    s_waitcnt vmcnt(7)
    ds_read_b64_tr_b16 v[112:113], v6 offset:0
    ds_read_b64_tr_b16 v[114:115], v6 offset:1024
    ds_read_b64_tr_b16 v[116:117], v7 offset:0
    ds_read_b64_tr_b16 v[118:119], v7 offset:1024
    s_waitcnt lgkmcnt(0)
    s_add_u32 m0, s44, 0
    s_add_u32 s51, s48, s55
    buffer_load_dwordx4 v4, s[28:31], s51 offen lds
    s_add_u32 s51, s51, 7168
    buffer_load_dwordx4 v4, s[28:31], s51 offen offset:1024 lds
    s_add_u32 s55, s55, 16384
    s_cmp_eq_u32 s55, 704512
    s_cselect_b32 s55, 0, s55
    s_add_u32 s51, s47, s64
    buffer_load_dwordx4 v[64:67], v3, s[8:11], s51 offen
    s_add_u32 s64, s64, 1024
    s_cmp_eq_u32 s64, 44032
    s_cselect_b32 s64, 0, s64
    v_mfma_f32_32x32x16_bf16 v[16:31], v[112:115], v[80:83], v[16:31]
    v_mfma_f32_32x32x16_bf16 v[32:47], v[116:119], v[80:83], v[32:47]
    s_waitcnt vmcnt(7)
    ds_read_b64_tr_b16 v[112:113], v6 offset:2048
    ds_read_b64_tr_b16 v[114:115], v6 offset:3072
    ds_read_b64_tr_b16 v[116:117], v7 offset:2048
    ds_read_b64_tr_b16 v[118:119], v7 offset:3072
    s_waitcnt lgkmcnt(0)
    s_add_u32 m0, s44, 2048
    s_add_u32 s51, s48, s55
    buffer_load_dwordx4 v4, s[28:31], s51 offen lds
    s_add_u32 s51, s51, 7168
    buffer_load_dwordx4 v4, s[28:31], s51 offen offset:1024 lds
    s_add_u32 s55, s55, 16384
    s_cmp_eq_u32 s55, 704512
    s_cselect_b32 s55, 0, s55
    s_add_u32 s51, s47, s64
    buffer_load_dwordx4 v[68:71], v3, s[8:11], s51 offen
    s_add_u32 s64, s64, 1024
    s_cmp_eq_u32 s64, 44032
    s_cselect_b32 s64, 0, s64
    v_mfma_f32_32x32x16_bf16 v[16:31], v[112:115], v[84:87], v[16:31]
    v_mfma_f32_32x32x16_bf16 v[32:47], v[116:119], v[84:87], v[32:47]
    s_waitcnt vmcnt(7)
    ds_read_b64_tr_b16 v[112:113], v6 offset:4096
    ds_read_b64_tr_b16 v[114:115], v6 offset:5120
    ds_read_b64_tr_b16 v[116:117], v7 offset:4096
    ds_read_b64_tr_b16 v[118:119], v7 offset:5120
    s_waitcnt lgkmcnt(0)
    s_add_u32 m0, s44, 4096
    s_add_u32 s51, s48, s55
    buffer_load_dwordx4 v4, s[28:31], s51 offen lds
    s_add_u32 s51, s51, 7168
    buffer_load_dwordx4 v4, s[28:31], s51 offen offset:1024 lds
    s_add_u32 s55, s55, 16384
    s_cmp_eq_u32 s55, 704512
    s_cselect_b32 s55, 0, s55
    s_add_u32 s51, s47, s64
    buffer_load_dwordx4 v[72:75], v3, s[8:11], s51 offen
    s_add_u32 s64, s64, 1024
    s_cmp_eq_u32 s64, 44032
    s_cselect_b32 s64, 0, s64
    v_mfma_f32_32x32x16_bf16 v[16:31], v[112:115], v[88:91], v[16:31]
    v_mfma_f32_32x32x16_bf16 v[32:47], v[116:119], v[88:91], v[32:47]
    s_waitcnt vmcnt(7)
    ds_read_b64_tr_b16 v[112:113], v6 offset:0
    ds_read_b64_tr_b16 v[114:115], v6 offset:1024
    ds_read_b64_tr_b16 v[116:117], v7 offset:0
    ds_read_b64_tr_b16 v[118:119], v7 offset:1024
    s_waitcnt lgkmcnt(0)
    s_add_u32 m0, s44, 0
    s_add_u32 s51, s48, s55
    buffer_load_dwordx4 v4, s[28:31], s51 offen lds
    s_add_u32 s51, s51, 7168
    buffer_load_dwordx4 v4, s[28:31], s51 offen offset:1024 lds
    s_add_u32 s55, s55, 16384
    s_cmp_eq_u32 s55, 704512
    s_cselect_b32 s55, 0, s55
    s_add_u32 s51, s47, s64
    buffer_load_dwordx4 v[76:79], v3, s[8:11], s51 offen
    s_add_u32 s64, s64, 1024
    s_cmp_eq_u32 s64, 44032
    s_cselect_b32 s64, 0, s64
    v_mfma_f32_32x32x16_bf16 v[16:31], v[112:115], v[92:95], v[16:31]
    v_mfma_f32_32x32x16_bf16 v[32:47], v[116:119], v[92:95], v[32:47]
    s_waitcnt vmcnt(7)
    ds_read_b64_tr_b16 v[112:113], v6 offset:2048
    ds_read_b64_tr_b16 v[114:115], v6 offset:3072
    ds_read_b64_tr_b16 v[116:117], v7 offset:2048
    ds_read_b64_tr_b16 v[118:119], v7 offset:3072
    s_waitcnt lgkmcnt(0)
    s_add_u32 m0, s44, 2048
    s_add_u32 s51, s48, s55
    buffer_load_dwordx4 v4, s[28:31], s51 offen lds
    s_add_u32 s51, s51, 7168
    buffer_load_dwordx4 v4, s[28:31], s51 offen offset:1024 lds
    s_add_u32 s55, s55, 16384
    s_cmp_eq_u32 s55, 704512
    s_cselect_b32 s55, 0, s55
    s_add_u32 s51, s47, s64
    buffer_load_dwordx4 v[80:83], v3, s[8:11], s51 offen
    s_add_u32 s64, s64, 1024
    s_cmp_eq_u32 s64, 44032
    s_cselect_b32 s64, 0, s64
    v_mfma_f32_32x32x16_bf16 v[16:31], v[112:115], v[96:99], v[16:31]
    v_mfma_f32_32x32x16_bf16 v[32:47], v[116:119], v[96:99], v[32:47]
    s_waitcnt vmcnt(7)
    ds_read_b64_tr_b16 v[112:113], v6 offset:4096
    ds_read_b64_tr_b16 v[114:115], v6 offset:5120
    ds_read_b64_tr_b16 v[116:117], v7 offset:4096
    ds_read_b64_tr_b16 v[118:119], v7 offset:5120
    s_waitcnt lgkmcnt(0)
    s_add_u32 m0, s44, 4096
    s_add_u32 s51, s48, s55
    buffer_load_dwordx4 v4, s[28:31], s51 offen lds
    s_add_u32 s51, s51, 7168
    buffer_load_dwordx4 v4, s[28:31], s51 offen offset:1024 lds
    s_add_u32 s55, s55, 16384
    s_cmp_eq_u32 s55, 704512
    s_cselect_b32 s55, 0, s55
    s_add_u32 s51, s47, s64
    buffer_load_dwordx4 v[84:87], v3, s[8:11], s51 offen
    s_add_u32 s64, s64, 1024
    s_cmp_eq_u32 s64, 44032
    s_cselect_b32 s64, 0, s64
    v_mfma_f32_32x32x16_bf16 v[16:31], v[112:115], v[100:103], v[16:31]
    v_mfma_f32_32x32x16_bf16 v[32:47], v[116:119], v[100:103], v[32:47]
    s_waitcnt vmcnt(7)
    ds_read_b64_tr_b16 v[112:113], v6 offset:0
    ds_read_b64_tr_b16 v[114:115], v6 offset:1024
    ds_read_b64_tr_b16 v[116:117], v7 offset:0
    ds_read_b64_tr_b16 v[118:119], v7 offset:1024
    s_waitcnt lgkmcnt(0)
    s_add_u32 m0, s44, 0
    s_add_u32 s51, s48, s55
    buffer_load_dwordx4 v4, s[28:31], s51 offen lds
    s_add_u32 s51, s51, 7168
    buffer_load_dwordx4 v4, s[28:31], s51 offen offset:1024 lds
    s_add_u32 s55, s55, 16384
    s_cmp_eq_u32 s55, 704512
    s_cselect_b32 s55, 0, s55
    s_add_u32 s51, s47, s64
    buffer_load_dwordx4 v[88:91], v3, s[8:11], s51 offen
    s_add_u32 s64, s64, 1024
    s_cmp_eq_u32 s64, 44032
    s_cselect_b32 s64, 0, s64
    v_mfma_f32_32x32x16_bf16 v[16:31], v[112:115], v[104:107], v[16:31]
    v_mfma_f32_32x32x16_bf16 v[32:47], v[116:119], v[104:107], v[32:47]
    s_mov_b32 s13, 2097152
M_G_P1:
    ds_read_b32 v5, v14 offset:68
    s_waitcnt lgkmcnt(0)
    v_readfirstlane_b32 s17, v5
    s_cmp_eq_u32 s17, 8
    s_cbranch_scc1 M_G_P1D
    s_sleep 4
    s_sub_u32 s13, s13, 1
    s_cbranch_scc0 M_G_P1
M_G_P1D:
    s_lshl_b32 s13, s22, 14
    s_add_u32 s65, s45, s13
    s_lshl_b32 s66, s12, 17
    s_add_u32 s66, s66, s49
    s_add_u32 m0, s65, 0
    s_add_u32 s51, s66, 0
    buffer_load_dwordx4 v4, s[56:59], s51 offen lds
    s_add_u32 m0, s65, 1024
    s_add_u32 s51, s66, 8192
    buffer_load_dwordx4 v4, s[56:59], s51 offen lds
    s_waitcnt vmcnt(9)
    ds_read_b64_tr_b16 v[112:113], v6 offset:2048
    ds_read_b64_tr_b16 v[114:115], v6 offset:3072
    ds_read_b64_tr_b16 v[116:117], v7 offset:2048
    ds_read_b64_tr_b16 v[118:119], v7 offset:3072
    s_waitcnt lgkmcnt(0)
    s_add_u32 m0, s44, 2048
    s_add_u32 s51, s48, s55
    buffer_load_dwordx4 v4, s[28:31], s51 offen lds
    s_add_u32 s51, s51, 7168
    buffer_load_dwordx4 v4, s[28:31], s51 offen offset:1024 lds
    s_add_u32 s55, s55, 16384
    s_cmp_eq_u32 s55, 704512
    s_cselect_b32 s55, 0, s55
    v_mfma_f32_32x32x16_bf16 v[16:31], v[112:115], v[108:111], v[16:31]
    v_mfma_f32_32x32x16_bf16 v[32:47], v[116:119], v[108:111], v[32:47]
    s_add_u32 m0, s65, 2048
    s_add_u32 s51, s66, 16384
    buffer_load_dwordx4 v4, s[56:59], s51 offen lds
    s_add_u32 m0, s65, 3072
    s_add_u32 s51, s66, 24576
    buffer_load_dwordx4 v4, s[56:59], s51 offen lds
    s_waitcnt vmcnt(10)
    ds_read_b64_tr_b16 v[112:113], v6 offset:4096
    ds_read_b64_tr_b16 v[114:115], v6 offset:5120
    ds_read_b64_tr_b16 v[116:117], v7 offset:4096
    ds_read_b64_tr_b16 v[118:119], v7 offset:5120
    s_waitcnt lgkmcnt(0)
    s_add_u32 m0, s44, 4096
    s_add_u32 s51, s48, s55
    buffer_load_dwordx4 v4, s[28:31], s51 offen lds
    s_add_u32 s51, s51, 7168
    buffer_load_dwordx4 v4, s[28:31], s51 offen offset:1024 lds
    s_add_u32 s55, s55, 16384
    s_cmp_eq_u32 s55, 704512
    s_cselect_b32 s55, 0, s55
    v_mfma_f32_32x32x16_bf16 v[16:31], v[112:115], v[48:51], v[16:31]
    v_mfma_f32_32x32x16_bf16 v[32:47], v[116:119], v[48:51], v[32:47]
    s_add_u32 m0, s65, 4096
    s_add_u32 s51, s66, 32768
    buffer_load_dwordx4 v4, s[56:59], s51 offen lds
    s_add_u32 m0, s65, 5120
    s_add_u32 s51, s66, 40960
    buffer_load_dwordx4 v4, s[56:59], s51 offen lds
    s_waitcnt vmcnt(11)
    ds_read_b64_tr_b16 v[112:113], v6 offset:0
    ds_read_b64_tr_b16 v[114:115], v6 offset:1024
    ds_read_b64_tr_b16 v[116:117], v7 offset:0
    ds_read_b64_tr_b16 v[118:119], v7 offset:1024
    s_waitcnt lgkmcnt(0)
    s_add_u32 m0, s44, 0
    s_add_u32 s51, s48, s55
    buffer_load_dwordx4 v4, s[28:31], s51 offen lds
    s_add_u32 s51, s51, 7168
    buffer_load_dwordx4 v4, s[28:31], s51 offen offset:1024 lds
    s_add_u32 s55, s55, 16384
    s_cmp_eq_u32 s55, 704512
    s_cselect_b32 s55, 0, s55
    v_mfma_f32_32x32x16_bf16 v[16:31], v[112:115], v[52:55], v[16:31]
    v_mfma_f32_32x32x16_bf16 v[32:47], v[116:119], v[52:55], v[32:47]
    s_add_u32 m0, s65, 6144
    s_add_u32 s51, s66, 49152
    buffer_load_dwordx4 v4, s[56:59], s51 offen lds
    s_add_u32 m0, s65, 7168
    s_add_u32 s51, s66, 57344
    buffer_load_dwordx4 v4, s[56:59], s51 offen lds
    s_waitcnt vmcnt(10)
    ds_read_b64_tr_b16 v[112:113], v6 offset:2048
    ds_read_b64_tr_b16 v[114:115], v6 offset:3072
    ds_read_b64_tr_b16 v[116:117], v7 offset:2048
    ds_read_b64_tr_b16 v[118:119], v7 offset:3072
    s_waitcnt lgkmcnt(0)
    s_add_u32 m0, s44, 2048
    s_add_u32 s51, s48, s55
    buffer_load_dwordx4 v4, s[28:31], s51 offen lds
    s_add_u32 s51, s51, 7168
    buffer_load_dwordx4 v4, s[28:31], s51 offen offset:1024 lds
    s_add_u32 s55, s55, 16384
    s_cmp_eq_u32 s55, 704512
    s_cselect_b32 s55, 0, s55
    v_mfma_f32_32x32x16_bf16 v[16:31], v[112:115], v[56:59], v[16:31]
    v_mfma_f32_32x32x16_bf16 v[32:47], v[116:119], v[56:59], v[32:47]
    s_add_u32 m0, s65, 8192
    s_add_u32 s51, s66, 65536
    buffer_load_dwordx4 v4, s[56:59], s51 offen lds
    s_add_u32 m0, s65, 9216
    s_add_u32 s51, s66, 73728
    buffer_load_dwordx4 v4, s[56:59], s51 offen lds
    s_waitcnt vmcnt(10)
    ds_read_b64_tr_b16 v[112:113], v6 offset:4096
    ds_read_b64_tr_b16 v[114:115], v6 offset:5120
    ds_read_b64_tr_b16 v[116:117], v7 offset:4096
    ds_read_b64_tr_b16 v[118:119], v7 offset:5120
    s_waitcnt lgkmcnt(0)
    s_add_u32 m0, s44, 4096
    s_add_u32 s51, s48, s55
    buffer_load_dwordx4 v4, s[28:31], s51 offen lds
    s_add_u32 s51, s51, 7168
    buffer_load_dwordx4 v4, s[28:31], s51 offen offset:1024 lds
    s_add_u32 s55, s55, 16384
    s_cmp_eq_u32 s55, 704512
    s_cselect_b32 s55, 0, s55
    v_mfma_f32_32x32x16_bf16 v[16:31], v[112:115], v[60:63], v[16:31]
    v_mfma_f32_32x32x16_bf16 v[32:47], v[116:119], v[60:63], v[32:47]
    s_add_u32 m0, s65, 10240
    s_add_u32 s51, s66, 81920
    buffer_load_dwordx4 v4, s[56:59], s51 offen lds
    s_add_u32 m0, s65, 11264
    s_add_u32 s51, s66, 90112
    buffer_load_dwordx4 v4, s[56:59], s51 offen lds
    s_waitcnt vmcnt(10)
    ds_read_b64_tr_b16 v[112:113], v6 offset:0
    ds_read_b64_tr_b16 v[114:115], v6 offset:1024
    ds_read_b64_tr_b16 v[116:117], v7 offset:0
    ds_read_b64_tr_b16 v[118:119], v7 offset:1024
    s_waitcnt lgkmcnt(0)
    s_add_u32 m0, s44, 0
    s_add_u32 s51, s48, s55
    buffer_load_dwordx4 v4, s[28:31], s51 offen lds
    s_add_u32 s51, s51, 7168
    buffer_load_dwordx4 v4, s[28:31], s51 offen offset:1024 lds
    s_add_u32 s55, s55, 16384
    s_cmp_eq_u32 s55, 704512
    s_cselect_b32 s55, 0, s55
    v_mfma_f32_32x32x16_bf16 v[16:31], v[112:115], v[64:67], v[16:31]
    v_mfma_f32_32x32x16_bf16 v[32:47], v[116:119], v[64:67], v[32:47]
    s_add_u32 m0, s65, 12288
    s_add_u32 s51, s66, 98304
    buffer_load_dwordx4 v4, s[56:59], s51 offen lds
    s_add_u32 m0, s65, 13312
    s_add_u32 s51, s66, 106496
    buffer_load_dwordx4 v4, s[56:59], s51 offen lds
    s_waitcnt vmcnt(10)
    ds_read_b64_tr_b16 v[112:113], v6 offset:2048
    ds_read_b64_tr_b16 v[114:115], v6 offset:3072
    ds_read_b64_tr_b16 v[116:117], v7 offset:2048
    ds_read_b64_tr_b16 v[118:119], v7 offset:3072
    s_waitcnt lgkmcnt(0)
    s_add_u32 m0, s44, 2048
    s_add_u32 s51, s48, s55
    buffer_load_dwordx4 v4, s[28:31], s51 offen lds
    s_add_u32 s51, s51, 7168
    buffer_load_dwordx4 v4, s[28:31], s51 offen offset:1024 lds
    s_add_u32 s55, s55, 16384
    s_cmp_eq_u32 s55, 704512
    s_cselect_b32 s55, 0, s55
    v_mfma_f32_32x32x16_bf16 v[16:31], v[112:115], v[68:71], v[16:31]
    v_mfma_f32_32x32x16_bf16 v[32:47], v[116:119], v[68:71], v[32:47]
    s_add_u32 m0, s65, 14336
    s_add_u32 s51, s66, 114688
    buffer_load_dwordx4 v4, s[56:59], s51 offen lds
    s_add_u32 m0, s65, 15360
    s_add_u32 s51, s66, 122880
    buffer_load_dwordx4 v4, s[56:59], s51 offen lds
    s_waitcnt vmcnt(10)
    ds_read_b64_tr_b16 v[112:113], v6 offset:4096
    ds_read_b64_tr_b16 v[114:115], v6 offset:5120
    ds_read_b64_tr_b16 v[116:117], v7 offset:4096
    ds_read_b64_tr_b16 v[118:119], v7 offset:5120
    s_waitcnt lgkmcnt(0)
    s_add_u32 m0, s44, 4096
    s_add_u32 s51, s48, s55
    buffer_load_dwordx4 v4, s[28:31], s51 offen lds
    s_add_u32 s51, s51, 7168
    buffer_load_dwordx4 v4, s[28:31], s51 offen offset:1024 lds
    s_add_u32 s55, s55, 16384
    s_cmp_eq_u32 s55, 704512
    s_cselect_b32 s55, 0, s55
    v_mfma_f32_32x32x16_bf16 v[16:31], v[112:115], v[72:75], v[16:31]
    v_mfma_f32_32x32x16_bf16 v[32:47], v[116:119], v[72:75], v[32:47]
    s_waitcnt vmcnt(8)
    ds_read_b64_tr_b16 v[112:113], v6 offset:0
    ds_read_b64_tr_b16 v[114:115], v6 offset:1024
    ds_read_b64_tr_b16 v[116:117], v7 offset:0
    ds_read_b64_tr_b16 v[118:119], v7 offset:1024
    s_waitcnt lgkmcnt(0)
    s_add_u32 m0, s44, 0
    s_add_u32 s51, s48, s55
    buffer_load_dwordx4 v4, s[28:31], s51 offen lds
    s_add_u32 s51, s51, 7168
    buffer_load_dwordx4 v4, s[28:31], s51 offen offset:1024 lds
    s_add_u32 s55, s55, 16384
    s_cmp_eq_u32 s55, 704512
    s_cselect_b32 s55, 0, s55
    v_mfma_f32_32x32x16_bf16 v[16:31], v[112:115], v[76:79], v[16:31]
    v_mfma_f32_32x32x16_bf16 v[32:47], v[116:119], v[76:79], v[32:47]
    s_waitcnt vmcnt(6)
    ds_read_b64_tr_b16 v[112:113], v6 offset:2048
    ds_read_b64_tr_b16 v[114:115], v6 offset:3072
    ds_read_b64_tr_b16 v[116:117], v7 offset:2048
    ds_read_b64_tr_b16 v[118:119], v7 offset:3072
    s_waitcnt lgkmcnt(0)
    v_mfma_f32_32x32x16_bf16 v[16:31], v[112:115], v[80:83], v[16:31]
    v_mfma_f32_32x32x16_bf16 v[32:47], v[116:119], v[80:83], v[32:47]
    s_waitcnt vmcnt(2)
    ds_read_b64_tr_b16 v[112:113], v6 offset:4096
    ds_read_b64_tr_b16 v[114:115], v6 offset:5120
    ds_read_b64_tr_b16 v[116:117], v7 offset:4096
    ds_read_b64_tr_b16 v[118:119], v7 offset:5120
    s_waitcnt lgkmcnt(0)
    v_mfma_f32_32x32x16_bf16 v[16:31], v[112:115], v[84:87], v[16:31]
    v_mfma_f32_32x32x16_bf16 v[32:47], v[116:119], v[84:87], v[32:47]
    s_waitcnt vmcnt(0)
    ds_read_b64_tr_b16 v[112:113], v6 offset:0
    ds_read_b64_tr_b16 v[114:115], v6 offset:1024
    ds_read_b64_tr_b16 v[116:117], v7 offset:0
    ds_read_b64_tr_b16 v[118:119], v7 offset:1024
    s_waitcnt lgkmcnt(0)
    v_mfma_f32_32x32x16_bf16 v[16:31], v[112:115], v[88:91], v[16:31]
    v_mfma_f32_32x32x16_bf16 v[32:47], v[116:119], v[88:91], v[32:47]
    s_mov_b64 exec, 1
    ds_add_u32 v14, v13 offset:24
    s_mov_b64 exec, -1
    s_lshl_b32 s54, s46, 5
    s_lshl_b32 s13, s23, 4
    s_add_u32 s54, s54, s13
    s_lshl_b32 s50, s19, 7
    s_add_u32 s50, s50, 10827776
    s_lshl_b32 s54, s54, 10
    s_add_u32 s54, s54, 2162688
    s_waitcnt vmcnt(0)

    ds_write_b32 v12, v13 offset:32
    v_xor_b32 v15, 4, v12
    s_setprio 3
    s_mov_b32 s13, 2097152
M_G_WF:
    ds_read_b32 v5, v15 offset:32
    s_waitcnt lgkmcnt(0)
    v_readfirstlane_b32 s17, v5
    s_cmp_eq_u32 s17, 1
    s_cbranch_scc1 M_G_WFD
    s_sleep 2
    s_sub_u32 s13, s13, 1
    s_cbranch_scc0 M_G_WF
M_G_WFD:
    s_mov_b32 s13, 2097152
M_G_OD:
    ds_read_b32 v5, v14 offset:108
    s_waitcnt lgkmcnt(0)
    v_readfirstlane_b32 s17, v5
    s_cmp_eq_u32 s17, 8
    s_cbranch_scc1 M_G_ODD
    s_sleep 2
    s_sub_u32 s13, s13, 1
    s_cbranch_scc0 M_G_OD
M_G_ODD:
    ds_read_b64_tr_b16 v[112:113], v10 offset:0
    ds_read_b64_tr_b16 v[114:115], v10 offset:1024
    ds_read_b64_tr_b16 v[116:117], v11 offset:0
    ds_read_b64_tr_b16 v[118:119], v11 offset:1024
    v_lshlrev_b32 v107, 2, v2
    s_cmp_lg_u32 s12, 0
    s_cbranch_scc1 M_G_OPO
    s_mov_b32 s13, 131072
    s_mov_b64 exec, 255
    buffer_load_dword v102, v107, s[8:11], s50 offen sc1
    s_sleep 8
M_G_OP:
    buffer_load_dword v104, v107, s[8:11], s50 offen sc1
    s_waitcnt vmcnt(1)
    v_cmp_eq_u32 vcc, s18, v102
    v_mov_b32 v101, v103
    s_nop 0
    s_cmp_eq_u32 vcc_lo, 255
    s_cbranch_scc1 M_G_OPD
    buffer_load_dword v102, v107, s[8:11], s50 offen sc1
    s_waitcnt vmcnt(1)
    v_cmp_eq_u32 vcc, s18, v104
    v_mov_b32 v101, v105
    s_nop 0
    s_cmp_eq_u32 vcc_lo, 255
    s_cbranch_scc1 M_G_OPD
    s_sub_u32 s13, s13, 1
    s_cbranch_scc0 M_G_OP
M_G_OPD:
    ds_write_b32 v14, v13 offset:104
    s_mov_b64 exec, -1
    s_branch M_G_OPX
M_G_OPO:
    s_mov_b32 s13, 2097152
M_G_OPL:
    ds_read_b32 v5, v14 offset:104
    s_waitcnt lgkmcnt(0)
    v_readfirstlane_b32 s17, v5
    s_cmp_eq_u32 s17, 1
    s_cbranch_scc1 M_G_OPLD
    s_sleep 1
    s_sub_u32 s13, s13, 1
    s_cbranch_scc0 M_G_OPL
M_G_OPLD:
M_G_OPX:
    buffer_load_dwordx4 v[48:51], v3, s[8:11], s54 offen offset:0
    buffer_load_dwordx4 v[52:55], v3, s[8:11], s54 offen offset:1024
    buffer_load_dwordx4 v[56:59], v3, s[8:11], s54 offen offset:2048
    buffer_load_dwordx4 v[60:63], v3, s[8:11], s54 offen offset:3072
    s_add_u32 s54, s54, 4096
    buffer_load_dwordx4 v[64:67], v3, s[8:11], s54 offen offset:0
    buffer_load_dwordx4 v[68:71], v3, s[8:11], s54 offen offset:1024
    buffer_load_dwordx4 v[72:75], v3, s[8:11], s54 offen offset:2048
    buffer_load_dwordx4 v[76:79], v3, s[8:11], s54 offen offset:3072
    s_add_u32 s54, s54, 4096
    buffer_load_dwordx4 v[80:83], v3, s[8:11], s54 offen offset:0
    buffer_load_dwordx4 v[84:87], v3, s[8:11], s54 offen offset:1024
    buffer_load_dwordx4 v[88:91], v3, s[8:11], s54 offen offset:2048
    buffer_load_dwordx4 v[92:95], v3, s[8:11], s54 offen offset:3072
    s_add_u32 s54, s54, 4096
    buffer_load_dwordx4 v[96:99], v3, s[8:11], s54 offen offset:0
    buffer_load_dwordx4 v[100:103], v3, s[8:11], s54 offen offset:1024
    buffer_load_dwordx4 v[104:107], v3, s[8:11], s54 offen offset:2048
    buffer_load_dwordx4 v[108:111], v3, s[8:11], s54 offen offset:3072
    ds_read_b64_tr_b16 v[120:121], v10 offset:2048
    ds_read_b64_tr_b16 v[122:123], v10 offset:3072
    ds_read_b64_tr_b16 v[124:125], v11 offset:2048
    ds_read_b64_tr_b16 v[126:127], v11 offset:3072
    s_waitcnt vmcnt(15) lgkmcnt(4)
    v_mfma_f32_32x32x16_bf16 v[16:31], v[112:115], v[48:51], v[16:31]
    v_mfma_f32_32x32x16_bf16 v[32:47], v[116:119], v[48:51], v[32:47]
    ds_read_b64_tr_b16 v[112:113], v10 offset:4096
    ds_read_b64_tr_b16 v[114:115], v10 offset:5120
    ds_read_b64_tr_b16 v[116:117], v11 offset:4096
    ds_read_b64_tr_b16 v[118:119], v11 offset:5120
    s_waitcnt vmcnt(14) lgkmcnt(4)
    v_mfma_f32_32x32x16_bf16 v[16:31], v[120:123], v[52:55], v[16:31]
    v_mfma_f32_32x32x16_bf16 v[32:47], v[124:127], v[52:55], v[32:47]
    ds_read_b64_tr_b16 v[120:121], v10 offset:6144
    ds_read_b64_tr_b16 v[122:123], v10 offset:7168
    ds_read_b64_tr_b16 v[124:125], v11 offset:6144
    ds_read_b64_tr_b16 v[126:127], v11 offset:7168
    s_waitcnt vmcnt(13) lgkmcnt(4)
    v_mfma_f32_32x32x16_bf16 v[16:31], v[112:115], v[56:59], v[16:31]
    v_mfma_f32_32x32x16_bf16 v[32:47], v[116:119], v[56:59], v[32:47]
    ds_read_b64_tr_b16 v[112:113], v10 offset:8192
    ds_read_b64_tr_b16 v[114:115], v10 offset:9216
    ds_read_b64_tr_b16 v[116:117], v11 offset:8192
    ds_read_b64_tr_b16 v[118:119], v11 offset:9216
    s_waitcnt vmcnt(12) lgkmcnt(4)
    v_mfma_f32_32x32x16_bf16 v[16:31], v[120:123], v[60:63], v[16:31]
    v_mfma_f32_32x32x16_bf16 v[32:47], v[124:127], v[60:63], v[32:47]
    ds_read_b64_tr_b16 v[120:121], v10 offset:10240
    ds_read_b64_tr_b16 v[122:123], v10 offset:11264
    ds_read_b64_tr_b16 v[124:125], v11 offset:10240
    ds_read_b64_tr_b16 v[126:127], v11 offset:11264
    s_waitcnt vmcnt(11) lgkmcnt(4)
    v_mfma_f32_32x32x16_bf16 v[16:31], v[112:115], v[64:67], v[16:31]
    v_mfma_f32_32x32x16_bf16 v[32:47], v[116:119], v[64:67], v[32:47]
    ds_read_b64_tr_b16 v[112:113], v10 offset:12288
    ds_read_b64_tr_b16 v[114:115], v10 offset:13312
    ds_read_b64_tr_b16 v[116:117], v11 offset:12288
    ds_read_b64_tr_b16 v[118:119], v11 offset:13312
    s_waitcnt vmcnt(10) lgkmcnt(4)
    v_mfma_f32_32x32x16_bf16 v[16:31], v[120:123], v[68:71], v[16:31]
    v_mfma_f32_32x32x16_bf16 v[32:47], v[124:127], v[68:71], v[32:47]
    ds_read_b64_tr_b16 v[120:121], v10 offset:14336
    ds_read_b64_tr_b16 v[122:123], v10 offset:15360
    ds_read_b64_tr_b16 v[124:125], v11 offset:14336
    ds_read_b64_tr_b16 v[126:127], v11 offset:15360
    s_waitcnt vmcnt(9) lgkmcnt(4)
    v_mfma_f32_32x32x16_bf16 v[16:31], v[112:115], v[72:75], v[16:31]
    v_mfma_f32_32x32x16_bf16 v[32:47], v[116:119], v[72:75], v[32:47]
    ds_read_b64_tr_b16 v[112:113], v10 offset:16384
    ds_read_b64_tr_b16 v[114:115], v10 offset:17408
    ds_read_b64_tr_b16 v[116:117], v11 offset:16384
    ds_read_b64_tr_b16 v[118:119], v11 offset:17408
    s_waitcnt vmcnt(8) lgkmcnt(4)
    v_mfma_f32_32x32x16_bf16 v[16:31], v[120:123], v[76:79], v[16:31]
    v_mfma_f32_32x32x16_bf16 v[32:47], v[124:127], v[76:79], v[32:47]
    ds_read_b64_tr_b16 v[120:121], v10 offset:18432
    ds_read_b64_tr_b16 v[122:123], v10 offset:19456
    ds_read_b64_tr_b16 v[124:125], v11 offset:18432
    ds_read_b64_tr_b16 v[126:127], v11 offset:19456
    s_waitcnt vmcnt(7) lgkmcnt(4)
    v_mfma_f32_32x32x16_bf16 v[16:31], v[112:115], v[80:83], v[16:31]
    v_mfma_f32_32x32x16_bf16 v[32:47], v[116:119], v[80:83], v[32:47]
    ds_read_b64_tr_b16 v[112:113], v10 offset:20480
    ds_read_b64_tr_b16 v[114:115], v10 offset:21504
    ds_read_b64_tr_b16 v[116:117], v11 offset:20480
    ds_read_b64_tr_b16 v[118:119], v11 offset:21504
    s_waitcnt vmcnt(6) lgkmcnt(4)
    v_mfma_f32_32x32x16_bf16 v[16:31], v[120:123], v[84:87], v[16:31]
    v_mfma_f32_32x32x16_bf16 v[32:47], v[124:127], v[84:87], v[32:47]
    ds_read_b64_tr_b16 v[120:121], v10 offset:22528
    ds_read_b64_tr_b16 v[122:123], v10 offset:23552
    ds_read_b64_tr_b16 v[124:125], v11 offset:22528
    ds_read_b64_tr_b16 v[126:127], v11 offset:23552
    s_waitcnt vmcnt(5) lgkmcnt(4)
    v_mfma_f32_32x32x16_bf16 v[16:31], v[112:115], v[88:91], v[16:31]
    v_mfma_f32_32x32x16_bf16 v[32:47], v[116:119], v[88:91], v[32:47]
    ds_read_b64_tr_b16 v[112:113], v10 offset:24576
    ds_read_b64_tr_b16 v[114:115], v10 offset:25600
    ds_read_b64_tr_b16 v[116:117], v11 offset:24576
    ds_read_b64_tr_b16 v[118:119], v11 offset:25600
    s_waitcnt vmcnt(4) lgkmcnt(4)
    v_mfma_f32_32x32x16_bf16 v[16:31], v[120:123], v[92:95], v[16:31]
    v_mfma_f32_32x32x16_bf16 v[32:47], v[124:127], v[92:95], v[32:47]
    ds_read_b64_tr_b16 v[120:121], v10 offset:26624
    ds_read_b64_tr_b16 v[122:123], v10 offset:27648
    ds_read_b64_tr_b16 v[124:125], v11 offset:26624
    ds_read_b64_tr_b16 v[126:127], v11 offset:27648
    s_waitcnt vmcnt(3) lgkmcnt(4)
    v_mfma_f32_32x32x16_bf16 v[16:31], v[112:115], v[96:99], v[16:31]
    v_mfma_f32_32x32x16_bf16 v[32:47], v[116:119], v[96:99], v[32:47]
    ds_read_b64_tr_b16 v[112:113], v10 offset:28672
    ds_read_b64_tr_b16 v[114:115], v10 offset:29696
    ds_read_b64_tr_b16 v[116:117], v11 offset:28672
    ds_read_b64_tr_b16 v[118:119], v11 offset:29696
    s_waitcnt vmcnt(2) lgkmcnt(4)
    v_mfma_f32_32x32x16_bf16 v[16:31], v[120:123], v[100:103], v[16:31]
    v_mfma_f32_32x32x16_bf16 v[32:47], v[124:127], v[100:103], v[32:47]
    ds_read_b64_tr_b16 v[120:121], v10 offset:30720
    ds_read_b64_tr_b16 v[122:123], v10 offset:31744
    ds_read_b64_tr_b16 v[124:125], v11 offset:30720
    ds_read_b64_tr_b16 v[126:127], v11 offset:31744
    s_waitcnt vmcnt(1) lgkmcnt(4)
    v_mfma_f32_32x32x16_bf16 v[16:31], v[112:115], v[104:107], v[16:31]
    v_mfma_f32_32x32x16_bf16 v[32:47], v[116:119], v[104:107], v[32:47]
    s_waitcnt vmcnt(0) lgkmcnt(0)
    v_mfma_f32_32x32x16_bf16 v[16:31], v[120:123], v[108:111], v[16:31]
    v_mfma_f32_32x32x16_bf16 v[32:47], v[124:127], v[108:111], v[32:47]
    s_lshl_b32 s50, s12, 12
    s_add_u32 s50, s50, 49152
    s_xor_b32 s51, s50, 8192
    v_add_u32 v6, s50, v3
    v_add_u32 v7, s51, v3
    s_xor_b32 s13, s12, 2
    s_lshl_b32 s13, s13, 2
    s_add_u32 s13, s13, 163072
    v_mov_b32 v14, s13
    s_nop 3
    ds_write_b128 v6, v[32:35] offset:0
    ds_write_b128 v6, v[36:39] offset:1024
    ds_write_b128 v6, v[40:43] offset:2048
    ds_write_b128 v6, v[44:47] offset:3072
    s_waitcnt lgkmcnt(0)
    ds_write_b32 v12, v13 offset:0
    s_mov_b32 s13, 2097152
M_G_P2:
    ds_read_b32 v5, v14 offset:0
    s_waitcnt lgkmcnt(0)
    v_readfirstlane_b32 s17, v5
    s_cmp_eq_u32 s17, 1
    s_cbranch_scc1 M_G_P2D
    s_sleep 4
    s_sub_u32 s13, s13, 1
    s_cbranch_scc0 M_G_P2
M_G_P2D:
    ds_read_b128 v[48:51], v7 offset:0
    ds_read_b128 v[52:55], v7 offset:1024
    ds_read_b128 v[56:59], v7 offset:2048
    ds_read_b128 v[60:63], v7 offset:3072
    s_waitcnt lgkmcnt(0)
    v_pk_add_f32 v[16:17], v[16:17], v[48:49]
    v_pk_add_f32 v[18:19], v[18:19], v[50:51]
    v_pk_add_f32 v[20:21], v[20:21], v[52:53]
    v_pk_add_f32 v[22:23], v[22:23], v[54:55]
    v_pk_add_f32 v[24:25], v[24:25], v[56:57]
    v_pk_add_f32 v[26:27], v[26:27], v[58:59]
    v_pk_add_f32 v[28:29], v[28:29], v[60:61]
    v_pk_add_f32 v[30:31], v[30:31], v[62:63]
    s_nop 1
    v_permlane32_swap_b32 v16, v20
    v_permlane32_swap_b32 v17, v21
    v_permlane32_swap_b32 v18, v22
    v_permlane32_swap_b32 v19, v23
    v_permlane32_swap_b32 v24, v28
    v_permlane32_swap_b32 v25, v29
    v_permlane32_swap_b32 v26, v30
    v_permlane32_swap_b32 v27, v31
    s_nop 1
    v_pk_add_f32 v[16:17], v[16:17], v[144:145]
    v_pk_add_f32 v[18:19], v[18:19], v[146:147]
    v_pk_add_f32 v[20:21], v[20:21], v[148:149]
    v_pk_add_f32 v[22:23], v[22:23], v[150:151]
    v_pk_add_f32 v[24:25], v[24:25], v[152:153]
    v_pk_add_f32 v[26:27], v[26:27], v[154:155]
    v_pk_add_f32 v[28:29], v[28:29], v[156:157]
    v_pk_add_f32 v[30:31], v[30:31], v[158:159]
    v_cvt_pk_bf16_f32 v48, v16, v17
    v_cvt_pk_bf16_f32 v49, v18, v19
    v_cvt_pk_bf16_f32 v50, v20, v21
    v_cvt_pk_bf16_f32 v51, v22, v23
    v_cvt_pk_bf16_f32 v52, v24, v25
    v_cvt_pk_bf16_f32 v53, v26, v27
    v_cvt_pk_bf16_f32 v54, v28, v29
    v_cvt_pk_bf16_f32 v55, v30, v31
    buffer_store_dwordx4 v[48:51], v9, s[36:39], s52 offen
    buffer_store_dwordx4 v[52:55], v9, s[36:39], s52 offen offset:32
    s_endpgm
CODE_END:
.section .rodata,"a"
.p2align 6
.amdhsa_kernel parallel_sum__grouped_kv_mqa__dense_activation_gelu__prompt_kernel
  .amdhsa_next_free_vgpr 168
  .amdhsa_next_free_sgpr 102
  .amdhsa_accum_offset 168
  .amdhsa_group_segment_fixed_size 0
  .amdhsa_kernarg_size 104
  .amdhsa_user_sgpr_count 2
  .amdhsa_user_sgpr_kernarg_segment_ptr 1
  .amdhsa_system_sgpr_workgroup_id_x 1
.end_amdhsa_kernel
```
